```python
import torch

def _softmax(x, axis=-1):
    return torch.softmax(x, dim=axis)

def _gelu(x):
    return torch.nn.functional.gelu(x, approximate='tanh')

def _silu(x):
    return torch.nn.functional.silu(x)

def _sigmoid(x):
    return torch.sigmoid(x)

def _layernorm(x, axis=-1, eps=1e-05):
    m = x.mean(dim=axis, keepdim=True)
    v = x.var(dim=axis, keepdim=True, unbiased=False)
    return (x - m) / torch.sqrt(v + eps)

def _scatter_add(tgt, idx, src, axis=0):
    return tgt.clone().index_add_(axis, idx, src)

def _segment_sum(src, seg, n):
    out = torch.zeros((n,) + src.shape[1:], dtype=src.dtype)
    return out.index_add_(0, seg, src)

def _pad(x, pw):
    flat = tuple((v for pair in reversed(pw) for v in pair))
    return torch.nn.functional.pad(x, flat)
kernel_name = 'adaLN_cond__gqa_block_cached__dense_activation_relu__decode'

def setup_inputs():

    _w = lambda a: (lambda t: t.to(torch.bfloat16) if t.is_floating_point() else t)(torch.as_tensor(a))

    def _A_setup():
        B, Sq, D = (8, 1, 512)
        Hq, Hkv, Sk, Dh = (32, 8, 4096, 128)
        assert Hq % Hkv == 0, (Hq, Hkv)
        return {'x': _w((lambda *s: torch.randn(*s, dtype=torch.bfloat16) * 0.1)(B, Sq, D)), 'k_cache': _w((lambda *s: torch.randn(*s, dtype=torch.bfloat16) * 0.8)(B, Hkv, Sk, Dh)), 'v_cache': _w((lambda *s: torch.randn(*s, dtype=torch.bfloat16) * 0.8)(B, Hkv, Sk, Dh)), 'wq': _w((lambda *s: torch.randn(*s, dtype=torch.bfloat16) * 0.8)(D, Hq * Dh) * D ** (-0.5)), 'wo': _w((lambda *s: torch.randn(*s, dtype=torch.bfloat16) * 0.8)(Hq * Dh, D) * (Hq * Dh) ** (-0.5))}
    _A_in = _A_setup()

    def _B_setup():
        B, S, D, Dff = (8, 1, 512, 1792)
        return {'x': _w((lambda *s: torch.randn(*s, dtype=torch.bfloat16) * 0.1)(B, S, D)), 'w1': _w((lambda *s: torch.randn(*s, dtype=torch.bfloat16) * 0.1)(D, Dff)), 'w2': _w((lambda *s: torch.randn(*s, dtype=torch.bfloat16) * 0.1)(Dff, D))}
    _B_in = _B_setup()
    return {'A_x': _A_in['x'], 'A_k_cache': _A_in['k_cache'], 'A_v_cache': _A_in['v_cache'], 'A_wq': _A_in['wq'], 'A_wo': _A_in['wo'], 'B_x': _B_in['x'], 'B_w1': _B_in['w1'], 'B_w2': _B_in['w2'], 'c': _w((lambda *s: torch.randn(*s, dtype=torch.bfloat16) * 0.8)(8, 512) * 8.0), 'w_mod': _w((lambda *s: torch.randn(*s, dtype=torch.bfloat16) * 0.8)(512, 6 * 512) * 512 ** (-0.5) * 8.0)}

def reference(A_x, A_k_cache, A_v_cache, A_wq, A_wo, B_x, B_w1, B_w2, c, w_mod):

    def _A_ref(x, k_cache, v_cache, wq, wo):
        B, Sq, D = x.shape
        Hq, Dh = (32, 128)
        Hkv = k_cache.shape[1]
        rep = Hq // Hkv
        q = (lambda x, *d: x.permute(*d))((x @ wq).reshape(B, Sq, Hq, Dh), 0, 2, 1, 3)
        k = (lambda x, n, axis: torch.repeat_interleave(x, n, dim=axis))(k_cache, rep, axis=1)
        v = (lambda x, n, axis: torch.repeat_interleave(x, n, dim=axis))(v_cache, rep, axis=1)
        scores = torch.einsum('bhqd,bhkd->bhqk', q, k) * Dh ** (-0.5)
        p = _softmax(scores, axis=-1)
        o = torch.einsum('bhqk,bhkd->bhqd', p, v)
        return (lambda x, *d: x.permute(*d))(o, 0, 2, 1, 3).reshape(B, Sq, Hq * Dh) @ wo

    def _B_ref(x, w1, w2):
        h = torch.einsum('bsd,df->bsf', x, w1)
        zero = torch.zeros_like(h)
        h = torch.maximum(h, zero)
        return torch.einsum('bsf,fd->bsd', h, w2)
    x = A_x
    mod = (_silu(c) @ w_mod).reshape(c.shape[0], 6, 1, -1)
    sa, ca, ga, sb, cb, gb = (mod[:, 0].clone(), mod[:, 1].clone(), mod[:, 2].clone(), mod[:, 3].clone(), mod[:, 4].clone(), mod[:, 5].clone())
    h = _layernorm(x, axis=-1) * (1 + ca) + sa
    x = x + ga * _A_ref(h, A_k_cache, A_v_cache, A_wq, A_wo)
    h = _layernorm(x, axis=-1) * (1 + cb) + sb
    x = x + gb * _B_ref(h, B_w1, B_w2)
    return x
```

```asm
; @launch grid=(256,1,1) block=(512,1,1) lds=156736
.amdgcn_target "amdgcn-amd-amdhsa--gfx950"
.text
.globl adaLN_cond__gqa_block_cached__dense_activation_relu__decode_kernel
.p2align 8
.type adaLN_cond__gqa_block_cached__dense_activation_relu__decode_kernel,@function
adaLN_cond__gqa_block_cached__dense_activation_relu__decode_kernel:
s_cmp_ge_u32 s2, 256
s_cbranch_scc1 L_end
s_load_dwordx16 s[16:31], s[0:1], 0
s_load_dwordx8 s[32:39], s[0:1], 64
s_load_dwordx2 s[40:41], s[0:1], 96
s_getpc_b64 s[98:99]
L_pc:
s_lshl_b32 s74, s2, 2
s_add_u32 s74, s74, L_roles-L_pc
s_load_dword s81, s[98:99], s74
v_lshrrev_b32 v2, 6, v0
v_and_b32 v1, 63, v0
v_readfirstlane_b32 s3, v2
s_and_b32 s74, s2, 7
s_lshr_b32 s75, s2, 3
s_bcnt1_i32_b32 s76, s74
s_and_b32 s76, s76, 1
s_lshl_b32 s84, s75, 1
s_or_b32 s84, s84, s76
s_lshr_b32 s85, s74, 1
s_lshl_b32 s88, s84, 20
s_mul_i32 s89, s85, 143360
s_sub_u32 s77, s3, 1
s_lshl_b32 s77, s77, 12
s_add_u32 s89, s89, s77
s_mul_i32 s73, s84, 16384
s_add_u32 s89, s89, s73
s_add_u32 s78, s89, 0
s_and_b32 s78, s78, 0xfffff
s_add_u32 s78, s78, s88
v_bfe_u32 v12, v1, 2, 2
v_lshlrev_b32 v12, 8, v12
v_lshrrev_b32 v13, 4, v1
v_lshl_add_u32 v12, v13, 6, v12
v_and_b32 v13, 3, v1
v_lshl_add_u32 v10, v13, 4, v12
s_mov_b32 s50, 0x4000000
s_mov_b32 s51, 0x20000
s_waitcnt lgkmcnt(0)
s_mov_b32 s48, s18
s_and_b32 s49, s19, 0xffff
s_cmp_eq_u32 s3, 0
s_cbranch_scc1 L_skip_1
buffer_load_dwordx4 v[80:83], v10, s[48:51], s78 offen offset:0 nt
buffer_load_dwordx4 v[84:87], v10, s[48:51], s78 offen offset:1024 nt
buffer_load_dwordx4 v[88:91], v10, s[48:51], s78 offen offset:2048 nt
buffer_load_dwordx4 v[92:95], v10, s[48:51], s78 offen offset:3072 nt
L_skip_1:
s_mov_b32 s68, 0x3fb8aa3b
s_mov_b32 s69, 0xffff0000
s_mov_b32 s70, 0x05040100
s_mov_b32 s71, 0x07060302
s_mov_b32 s72, 0x3db504f3
s_mov_b32 s44, s40
s_and_b32 s45, s41, 0xffff
s_mov_b32 s46, 0x10000000
s_mov_b32 s47, 0x20000
v_mov_b32 v28, 1835008
buffer_load_dword v47, v28, s[44:47], 0 offen sc1
s_mov_b32 s52, s20
s_and_b32 s53, s21, 0xffff
s_mov_b32 s54, 0x4000000
s_mov_b32 s55, 0x20000
s_mov_b32 s93, 200000
s_and_b32 s42, s2, 31
s_lshr_b32 s43, s2, 5
s_and_b32 s86, s81, 15
s_bfe_u32 s87, s81, 0x80004
s_bfe_u32 s82, s81, 0x80014
s_bfe_u32 s81, s81, 0x40010
s_cmp_lg_u32 s3, 0
s_cbranch_scc1 L_skip_2
v_mov_b32 v12, -1
v_mov_b32 v13, -1
v_mov_b32 v14, -1
v_mov_b32 v15, -1
v_lshlrev_b32 v16, 4, v1
v_add_u32 v17, 130112, v16
ds_write_b128 v17, v[12:15]
s_nop 0
v_mov_b32 v17, 130048
v_mov_b32 v18, 0
v_mov_b32 v19, 0
ds_write_b64 v17, v[18:19]
ds_write_b64 v17, v[18:19] offset:8
ds_write_b64 v17, v[18:19] offset:16
s_cmp_lg_u32 s86, 0
s_cbranch_scc1 L_skip_3
s_waitcnt lgkmcnt(0)
s_barrier
L_skip_3:
s_cmp_ge_u32 s2, 8
s_cbranch_scc1 L_skip_4
s_lshl_b32 s74, s2, 10
s_add_u32 s74, s74, 1441792
buffer_store_dwordx4 v[12:15], v16, s[44:47], s74 offen sc1
L_skip_4:
s_mul_i32 s74, s2, 3072
s_add_u32 s74, s74, 655360
s_add_u32 s75, s74, 4096
buffer_store_dwordx4 v[12:15], v16, s[44:47], s74 offen offset:0 sc1
buffer_store_dwordx4 v[12:15], v16, s[44:47], s74 offen offset:1024 sc1
buffer_store_dwordx4 v[12:15], v16, s[44:47], s74 offen offset:2048 sc1
s_cmp_lg_u32 s86, 1
s_cbranch_scc1 L_skip_5
s_lshl_b32 s74, s87, 7
s_add_u32 s74, s74, 0
v_lshrrev_b32 v17, 3, v1
v_mul_u32_u24 v17, 6144, v17
v_and_b32 v18, 7, v1
v_lshl_add_u32 v17, v18, 4, v17
buffer_store_dwordx4 v[12:15], v17, s[44:47], s74 offen sc1
L_skip_5:
s_cmp_lg_u32 s86, 2
s_cbranch_scc1 L_skip_6
s_lshl_b32 s74, s87, 7
s_add_u32 s74, s74, 65536
v_lshrrev_b32 v17, 3, v1
v_mul_u32_u24 v17, 8192, v17
v_and_b32 v18, 7, v1
v_lshl_add_u32 v17, v18, 4, v17
buffer_store_dwordx4 v[12:15], v17, s[44:47], s74 offen sc1
L_skip_6:
s_mov_b64 exec, 15
s_and_b32 s74, s84, 7
s_lshl_b32 s74, s74, 14
s_lshl_b32 s75, s85, 10
s_add_u32 s74, s74, s75
s_lshr_b32 s75, s84, 3
s_lshl_b32 s75, s75, 7
s_add_u32 s74, s74, s75
s_add_u32 s74, s74, 1966080
v_lshlrev_b32 v17, 12, v1
buffer_store_dwordx2 v[12:13], v17, s[44:47], s74 offen sc1
s_mov_b64 exec, 1
s_cmp_lg_u32 s85, 0
s_cbranch_scc1 L_skip_7
v_mov_b32 v17, 0
s_mul_i32 s74, s84, 4096
s_add_u32 s74, s74, 3145728
buffer_store_dword v17, v16, s[44:47], s74 offen sc1
L_skip_7:
s_lshr_b32 s74, s2, 4
s_lshl_b32 s74, s74, 12
s_and_b32 s75, s2, 15
s_lshl_b32 s75, s75, 2
s_add_u32 s74, s74, s75
s_add_u32 s74, s74, 1839104
s_waitcnt vmcnt(0)
v_readfirstlane_b32 s80, v47
s_mul_i32 s80, s80, 0x9e3779b1
s_add_u32 s80, s80, 0x7f4a7c15
v_mov_b32 v17, s80
s_cmp_lg_u32 s86, 1
s_cbranch_scc1 L_skip_8
s_cmp_ge_u32 s87, 16
s_cbranch_scc1 L_skip_8
s_lshl_b32 s75, s87, 2
s_add_u32 s75, s75, 1933312
buffer_store_dword v17, v16, s[44:47], s75 offen sc1
L_skip_8:
s_cmp_lt_u32 s81, 3
s_cbranch_scc1 L_skip_9
s_getreg_b32 s76, hwreg(HW_REG_XCC_ID, 0, 4)
s_andn2_b32 s77, s80, 15
s_or_b32 s76, s76, s77
s_lshl_b32 s75, s82, 2
s_add_u32 s75, s75, 1941504
v_mov_b32 v18, s76
buffer_store_dword v18, v16, s[44:47], s75 offen sc1
L_skip_9:
buffer_store_dword v17, v16, s[44:47], s74 offen sc1
s_mov_b64 exec, -1
L_skip_2:
s_cmp_lg_u32 s86, 1
s_cbranch_scc1 L_skip_10
s_mov_b32 s56, s34
s_and_b32 s57, s35, 0xffff
s_mov_b32 s58, 0x300000
s_mov_b32 s59, 0x20000
s_mov_b32 s60, s32
s_and_b32 s61, s33, 0xffff
s_mov_b32 s62, 0x2000
s_mov_b32 s63, 0x20000
s_mul_i32 s74, s3, 1024
s_add_u32 s74, s74, 0
v_lshl_add_u32 v144, v1, 4, s74
buffer_load_dwordx4 v[148:151], v144, s[60:63], 0 offen
s_lshl_b32 s79, s87, 6
s_lshl_b32 s76, s3, 6
s_lshl_b32 s77, s79, 1
s_lshl_b32 s78, s3, 13
s_add_u32 s78, s78, 0
v_lshrrev_b32 v144, 3, v1
v_mul_u32_u24 v144, 6144, v144
v_and_b32 v145, 7, v1
v_lshl_add_u32 v144, v145, 4, v144
s_mul_i32 s74, s76, 6144
s_add_u32 s74, s74, s77
s_add_u32 m0, s78, 0
s_add_u32 s75, s74, 0
buffer_load_dwordx4 v144, s[56:59], s75 offen nt lds
s_add_u32 m0, s78, 1024
s_add_u32 s75, s74, 49152
buffer_load_dwordx4 v144, s[56:59], s75 offen nt lds
s_add_u32 m0, s78, 2048
s_add_u32 s75, s74, 98304
buffer_load_dwordx4 v144, s[56:59], s75 offen nt lds
s_add_u32 m0, s78, 3072
s_add_u32 s75, s74, 147456
buffer_load_dwordx4 v144, s[56:59], s75 offen nt lds
s_add_u32 m0, s78, 4096
s_add_u32 s75, s74, 196608
buffer_load_dwordx4 v144, s[56:59], s75 offen nt lds
s_add_u32 m0, s78, 5120
s_add_u32 s75, s74, 245760
buffer_load_dwordx4 v144, s[56:59], s75 offen nt lds
s_add_u32 m0, s78, 6144
s_add_u32 s75, s74, 294912
buffer_load_dwordx4 v144, s[56:59], s75 offen nt lds
s_add_u32 m0, s78, 7168
s_add_u32 s75, s74, 344064
buffer_load_dwordx4 v144, s[56:59], s75 offen nt lds
L_skip_10:
s_cmp_lg_u32 s86, 2
s_cbranch_scc1 L_skip_11
s_mov_b32 s56, s22
s_and_b32 s57, s23, 0xffff
s_mov_b32 s58, 0x400000
s_mov_b32 s59, 0x20000
s_mov_b32 s60, s16
s_and_b32 s61, s17, 0xffff
s_mov_b32 s62, 0x2000
s_mov_b32 s63, 0x20000
s_mul_i32 s74, s3, 1024
s_add_u32 s74, s74, 0
v_lshl_add_u32 v144, v1, 4, s74
buffer_load_dwordx4 v[148:151], v144, s[60:63], 0 offen
s_lshl_b32 s79, s87, 6
s_lshl_b32 s76, s3, 6
s_lshl_b32 s77, s79, 1
s_lshl_b32 s78, s3, 13
s_add_u32 s78, s78, 0
v_lshrrev_b32 v144, 3, v1
v_mul_u32_u24 v144, 8192, v144
v_and_b32 v145, 7, v1
v_lshl_add_u32 v144, v145, 4, v144
s_mul_i32 s74, s76, 8192
s_add_u32 s74, s74, s77
s_add_u32 m0, s78, 0
s_add_u32 s75, s74, 0
buffer_load_dwordx4 v144, s[56:59], s75 offen nt lds
s_add_u32 m0, s78, 1024
s_add_u32 s75, s74, 65536
buffer_load_dwordx4 v144, s[56:59], s75 offen nt lds
s_add_u32 m0, s78, 2048
s_add_u32 s75, s74, 131072
buffer_load_dwordx4 v144, s[56:59], s75 offen nt lds
s_add_u32 m0, s78, 3072
s_add_u32 s75, s74, 196608
buffer_load_dwordx4 v144, s[56:59], s75 offen nt lds
s_add_u32 m0, s78, 4096
s_add_u32 s75, s74, 262144
buffer_load_dwordx4 v144, s[56:59], s75 offen nt lds
s_add_u32 m0, s78, 5120
s_add_u32 s75, s74, 327680
buffer_load_dwordx4 v144, s[56:59], s75 offen nt lds
s_add_u32 m0, s78, 6144
s_add_u32 s75, s74, 393216
buffer_load_dwordx4 v144, s[56:59], s75 offen nt lds
s_add_u32 m0, s78, 7168
s_add_u32 s75, s74, 458752
buffer_load_dwordx4 v144, s[56:59], s75 offen nt lds
L_skip_11:
v_lshlrev_b32 v11, 4, v1
v_mov_b32 v8, 0xff7fffff
v_mov_b32 v9, 0
v_mov_b32 v48, 0
v_mov_b32 v49, 0
v_mov_b32 v50, 0
v_mov_b32 v51, 0
v_mov_b32 v52, 0
v_mov_b32 v53, 0
v_mov_b32 v54, 0
v_mov_b32 v55, 0
v_mov_b32 v56, 0
v_mov_b32 v57, 0
v_mov_b32 v58, 0
v_mov_b32 v59, 0
v_mov_b32 v60, 0
v_mov_b32 v61, 0
v_mov_b32 v62, 0
v_mov_b32 v63, 0
v_mov_b32 v64, 0
v_mov_b32 v65, 0
v_mov_b32 v66, 0
v_mov_b32 v67, 0
v_mov_b32 v68, 0
v_mov_b32 v69, 0
v_mov_b32 v70, 0
v_mov_b32 v71, 0
v_mov_b32 v72, 0
v_mov_b32 v73, 0
v_mov_b32 v74, 0
v_mov_b32 v75, 0
v_mov_b32 v76, 0
v_mov_b32 v77, 0
v_mov_b32 v78, 0
v_mov_b32 v79, 0
s_cmp_eq_u32 s86, 2
s_cbranch_scc1 L_role_q_12
s_cmp_lg_u32 s86, 1
s_cbranch_scc1 L_plain_14
s_waitcnt vmcnt(8)
v_lshlrev_b32 v160, 16, v148
v_and_b32 v161, s69, v148
v_lshlrev_b32 v162, 16, v149
v_and_b32 v163, s69, v149
v_lshlrev_b32 v164, 16, v150
v_and_b32 v165, s69, v150
v_lshlrev_b32 v166, 16, v151
v_and_b32 v167, s69, v151
v_mul_f32 v168, s68, v160
v_mul_f32 v169, s68, v161
v_mul_f32 v170, s68, v162
v_mul_f32 v171, s68, v163
v_mul_f32 v172, s68, v164
v_mul_f32 v173, s68, v165
v_mul_f32 v174, s68, v166
v_mul_f32 v175, s68, v167
v_exp_f32 v168, -v168
v_exp_f32 v169, -v169
v_exp_f32 v170, -v170
v_exp_f32 v171, -v171
v_exp_f32 v172, -v172
v_exp_f32 v173, -v173
v_exp_f32 v174, -v174
v_exp_f32 v175, -v175
v_add_f32 v168, 1.0, v168
v_add_f32 v169, 1.0, v169
v_add_f32 v170, 1.0, v170
v_add_f32 v171, 1.0, v171
v_add_f32 v172, 1.0, v172
v_add_f32 v173, 1.0, v173
v_add_f32 v174, 1.0, v174
v_add_f32 v175, 1.0, v175
v_rcp_f32 v176, v168
v_rcp_f32 v177, v169
v_rcp_f32 v178, v170
v_rcp_f32 v179, v171
v_rcp_f32 v180, v172
v_rcp_f32 v181, v173
v_rcp_f32 v182, v174
v_rcp_f32 v183, v175
v_mul_f32 v184, v160, v176
v_mul_f32 v185, v161, v177
v_mul_f32 v186, v162, v178
v_mul_f32 v187, v163, v179
v_mul_f32 v188, v164, v180
v_mul_f32 v189, v165, v181
v_mul_f32 v190, v166, v182
v_mul_f32 v191, v167, v183
v_fma_f32 v192, -v184, v168, v160
v_fma_f32 v193, -v185, v169, v161
v_fma_f32 v194, -v186, v170, v162
v_fma_f32 v195, -v187, v171, v163
v_fma_f32 v196, -v188, v172, v164
v_fma_f32 v197, -v189, v173, v165
v_fma_f32 v198, -v190, v174, v166
v_fma_f32 v199, -v191, v175, v167
v_fmac_f32 v184, v192, v176
v_fmac_f32 v185, v193, v177
v_fmac_f32 v186, v194, v178
v_fmac_f32 v187, v195, v179
v_fmac_f32 v188, v196, v180
v_fmac_f32 v189, v197, v181
v_fmac_f32 v190, v198, v182
v_fmac_f32 v191, v199, v183
v_div_fixup_f32 v184, v184, v168, v160
v_div_fixup_f32 v185, v185, v169, v161
v_div_fixup_f32 v186, v186, v170, v162
v_div_fixup_f32 v187, v187, v171, v163
v_div_fixup_f32 v188, v188, v172, v164
v_div_fixup_f32 v189, v189, v173, v165
v_div_fixup_f32 v190, v190, v174, v166
v_div_fixup_f32 v191, v191, v175, v167
v_cvt_pk_bf16_f32 v152, v184, v185
v_cvt_pk_bf16_f32 v153, v186, v187
v_cvt_pk_bf16_f32 v154, v188, v189
v_cvt_pk_bf16_f32 v155, v190, v191
s_waitcnt vmcnt(0)
s_lshl_b32 s78, s3, 13
s_add_u32 s78, s78, 0
v_lshrrev_b32 v144, 4, v1
v_lshlrev_b32 v144, 3, v144
v_bfe_u32 v145, v1, 2, 2
v_add_u32 v144, v144, v145
v_mul_u32_u24 v144, 128, v144
v_and_b32 v145, 3, v1
v_lshl_add_u32 v144, v145, 3, v144
v_add_u32 v144, s78, v144
ds_read_b64_tr_b16 v[112:113], v144 offset:0
ds_read_b64_tr_b16 v[114:115], v144 offset:512
ds_read_b64_tr_b16 v[116:117], v144 offset:32
ds_read_b64_tr_b16 v[118:119], v144 offset:544
ds_read_b64_tr_b16 v[120:121], v144 offset:64
ds_read_b64_tr_b16 v[122:123], v144 offset:576
ds_read_b64_tr_b16 v[124:125], v144 offset:96
ds_read_b64_tr_b16 v[126:127], v144 offset:608
ds_read_b64_tr_b16 v[128:129], v144 offset:4096
ds_read_b64_tr_b16 v[130:131], v144 offset:4608
ds_read_b64_tr_b16 v[132:133], v144 offset:4128
ds_read_b64_tr_b16 v[134:135], v144 offset:4640
ds_read_b64_tr_b16 v[136:137], v144 offset:4160
ds_read_b64_tr_b16 v[138:139], v144 offset:4672
ds_read_b64_tr_b16 v[140:141], v144 offset:4192
ds_read_b64_tr_b16 v[142:143], v144 offset:4704
s_mul_i32 s74, s3, 1056
s_add_u32 s74, s74, 65536
v_lshl_add_u32 v160, v1, 4, s74
ds_write_b128 v160, v[152:155]
v_and_b32 v161, 7, v1
v_mul_u32_u24 v161, 1056, v161
v_lshrrev_b32 v162, 4, v1
v_lshl_add_u32 v161, v162, 4, v161
s_lshl_b32 s74, s3, 7
s_add_u32 s74, s74, 65536
v_add_u32 v161, s74, v161
v_and_b32 v163, 15, v1
v_mul_u32_u24 v163, 272, v163
v_lshl_add_u32 v163, v162, 4, v163
s_mul_i32 s74, s3, 2176
s_add_u32 s74, s74, 74752
v_add_u32 v163, s74, v163
s_waitcnt lgkmcnt(0)
s_barrier
ds_read_b128 v[164:167], v161
ds_read_b128 v[168:171], v161 offset:64
s_waitcnt lgkmcnt(1)
v_mfma_f32_16x16x32_bf16 v[172:175], v[112:115], v[164:167], 0
v_mfma_f32_16x16x32_bf16 v[176:179], v[116:119], v[164:167], 0
v_mfma_f32_16x16x32_bf16 v[180:183], v[120:123], v[164:167], 0
v_mfma_f32_16x16x32_bf16 v[184:187], v[124:127], v[164:167], 0
s_waitcnt lgkmcnt(0)
v_mfma_f32_16x16x32_bf16 v[172:175], v[128:131], v[168:171], v[172:175]
v_mfma_f32_16x16x32_bf16 v[176:179], v[132:135], v[168:171], v[176:179]
v_mfma_f32_16x16x32_bf16 v[180:183], v[136:139], v[168:171], v[180:183]
v_mfma_f32_16x16x32_bf16 v[184:187], v[140:143], v[168:171], v[184:187]
s_mov_b32 exec_lo, 0x00ff00ff
s_mov_b32 exec_hi, 0x00ff00ff
s_nop 2
ds_write_b128 v163, v[172:175] offset:0
ds_write_b128 v163, v[176:179] offset:64
ds_write_b128 v163, v[180:183] offset:128
ds_write_b128 v163, v[184:187] offset:192
s_mov_b64 exec, -1
s_mul_i32 s74, s3, 272
s_add_u32 s74, s74, 74752
v_lshl_add_u32 v160, v1, 3, s74
s_waitcnt lgkmcnt(0)
s_barrier
s_mov_b32 exec_hi, 0
ds_read_b64 v[172:173], v160 offset:0
ds_read_b64 v[174:175], v160 offset:2176
ds_read_b64 v[176:177], v160 offset:4352
ds_read_b64 v[178:179], v160 offset:6528
ds_read_b64 v[180:181], v160 offset:8704
ds_read_b64 v[182:183], v160 offset:10880
ds_read_b64 v[184:185], v160 offset:13056
ds_read_b64 v[186:187], v160 offset:15232
s_waitcnt lgkmcnt(0)
v_add_f32 v172, v172, v174
v_add_f32 v176, v176, v178
v_add_f32 v180, v180, v182
v_add_f32 v184, v184, v186
v_add_f32 v173, v173, v175
v_add_f32 v177, v177, v179
v_add_f32 v181, v181, v183
v_add_f32 v185, v185, v187
v_add_f32 v172, v172, v176
v_add_f32 v180, v180, v184
v_add_f32 v173, v173, v177
v_add_f32 v181, v181, v185
v_add_f32 v168, v172, v180
v_add_f32 v169, v173, v181
v_cvt_pk_bf16_f32 v168, v168, v169
v_min_u32 v168, -2, v168
s_mul_i32 s74, s3, 6144
s_lshl_b32 s75, s87, 7
s_add_u32 s74, s74, s75
v_lshlrev_b32 v169, 2, v1
buffer_store_dword v168, v169, s[44:47], s74 offen sc1
s_mov_b64 exec, -1
s_branch L_static_13
L_role_q_12:
v_and_b32 v146, 15, v1
v_lshlrev_b32 v146, 2, v146
v_add_u32 v146, 1933312, v146
L_mf_15:
buffer_load_dword v147, v146, s[44:47], 0 offen sc1
s_waitcnt vmcnt(0)
v_readfirstlane_b32 s80, v47
s_mul_i32 s80, s80, 0x9e3779b1
s_add_u32 s80, s80, 0x7f4a7c15
v_cmp_ne_u32 vcc, s80, v147
s_cbranch_vccz L_mfok_16
s_sub_u32 s93, s93, 1
s_cbranch_scc1 L_end
s_branch L_mf_15
L_mfok_16:
s_mul_i32 s74, s3, 6144
s_add_u32 s74, s74, 0
v_lshl_add_u32 v146, v1, 4, s74
buffer_load_dwordx4 v[152:155], v146, s[44:47], 0 offen offset:1024 sc1
buffer_load_dwordx4 v[156:159], v146, s[44:47], 0 offen sc1
s_barrier
s_mul_i32 s74, s3, 1056
s_add_u32 s74, s74, 65536
v_lshl_add_u32 v144, v1, 4, s74
v_and_b32 v180, 7, v1
v_mul_u32_u24 v180, 1056, v180
v_lshrrev_b32 v147, 4, v1
v_lshl_add_u32 v180, v147, 4, v180
v_add_u32 v180, 65536, v180
s_cmp_ge_u32 s3, 4
s_cbranch_scc1 L_skip_17
s_lshl_b32 s78, s3, 5
s_add_u32 s78, s78, 0
v_lshrrev_b32 v182, 4, v1
v_lshlrev_b32 v182, 3, v182
v_bfe_u32 v183, v1, 2, 2
v_add_u32 v182, v182, v183
v_mul_u32_u24 v182, 128, v182
v_and_b32 v183, 3, v1
v_lshl_add_u32 v182, v183, 3, v182
v_add_u32 v182, s78, v182
ds_read_b64_tr_b16 v[192:193], v182 offset:0
ds_read_b64_tr_b16 v[194:195], v182 offset:512
ds_read_b64_tr_b16 v[196:197], v182 offset:4096
ds_read_b64_tr_b16 v[198:199], v182 offset:4608
ds_read_b64_tr_b16 v[200:201], v182 offset:8192
ds_read_b64_tr_b16 v[202:203], v182 offset:8704
ds_read_b64_tr_b16 v[204:205], v182 offset:12288
ds_read_b64_tr_b16 v[206:207], v182 offset:12800
ds_read_b64_tr_b16 v[208:209], v182 offset:16384
ds_read_b64_tr_b16 v[210:211], v182 offset:16896
ds_read_b64_tr_b16 v[212:213], v182 offset:20480
ds_read_b64_tr_b16 v[214:215], v182 offset:20992
ds_read_b64_tr_b16 v[216:217], v182 offset:24576
ds_read_b64_tr_b16 v[218:219], v182 offset:25088
ds_read_b64_tr_b16 v[220:221], v182 offset:28672
ds_read_b64_tr_b16 v[222:223], v182 offset:29184
ds_read_b64_tr_b16 v[224:225], v182 offset:32768
ds_read_b64_tr_b16 v[226:227], v182 offset:33280
ds_read_b64_tr_b16 v[228:229], v182 offset:36864
ds_read_b64_tr_b16 v[230:231], v182 offset:37376
ds_read_b64_tr_b16 v[232:233], v182 offset:40960
ds_read_b64_tr_b16 v[234:235], v182 offset:41472
ds_read_b64_tr_b16 v[236:237], v182 offset:45056
ds_read_b64_tr_b16 v[238:239], v182 offset:45568
ds_read_b64_tr_b16 v[240:241], v182 offset:49152
ds_read_b64_tr_b16 v[242:243], v182 offset:49664
ds_read_b64_tr_b16 v[244:245], v182 offset:53248
ds_read_b64_tr_b16 v[246:247], v182 offset:53760
ds_read_b64_tr_b16 v[248:249], v182 offset:57344
ds_read_b64_tr_b16 v[250:251], v182 offset:57856
ds_read_b64_tr_b16 v[252:253], v182 offset:61440
ds_read_b64_tr_b16 v[254:255], v182 offset:61952
L_skip_17:
s_waitcnt vmcnt(0)
s_branch L_pollchk_20
L_poll_18:
buffer_load_dwordx4 v[152:155], v146, s[44:47], 0 offen offset:1024 sc1
buffer_load_dwordx4 v[156:159], v146, s[44:47], 0 offen sc1
s_waitcnt vmcnt(0)
L_pollchk_20:
v_max3_u32 v160, v152, v153, v154
v_max3_u32 v161, v155, v156, v157
v_max3_u32 v160, v160, v158, v159
v_max_u32 v160, v160, v161
v_cmp_eq_u32 vcc, -1, v160
s_cbranch_vccz L_pollok_19
s_sub_u32 s93, s93, 1
s_cbranch_scc1 L_end
s_branch L_poll_18
L_pollok_19:
v_lshlrev_b32 v160, 16, v152
v_and_b32 v161, s69, v152
v_lshlrev_b32 v162, 16, v153
v_and_b32 v163, s69, v153
v_lshlrev_b32 v164, 16, v154
v_and_b32 v165, s69, v154
v_lshlrev_b32 v166, 16, v155
v_and_b32 v167, s69, v155
v_add_f32 v160, 1.0, v160
v_add_f32 v161, 1.0, v161
v_add_f32 v162, 1.0, v162
v_add_f32 v163, 1.0, v163
v_add_f32 v164, 1.0, v164
v_add_f32 v165, 1.0, v165
v_add_f32 v166, 1.0, v166
v_add_f32 v167, 1.0, v167
v_cvt_pk_bf16_f32 v152, v160, v161
v_cvt_pk_bf16_f32 v153, v162, v163
v_cvt_pk_bf16_f32 v154, v164, v165
v_cvt_pk_bf16_f32 v155, v166, v167
v_lshlrev_b32 v160, 16, v152
v_and_b32 v161, s69, v152
v_lshlrev_b32 v162, 16, v153
v_and_b32 v163, s69, v153
v_lshlrev_b32 v164, 16, v154
v_and_b32 v165, s69, v154
v_lshlrev_b32 v166, 16, v155
v_and_b32 v167, s69, v155
v_lshlrev_b32 v168, 16, v156
v_and_b32 v169, s69, v156
v_lshlrev_b32 v170, 16, v157
v_and_b32 v171, s69, v157
v_lshlrev_b32 v172, 16, v158
v_and_b32 v173, s69, v158
v_lshlrev_b32 v174, 16, v159
v_and_b32 v175, s69, v159
v_readfirstlane_b32 s76, v148
v_lshlrev_b32 v112, 16, v148
v_and_b32 v113, s69, v148
v_lshlrev_b32 v114, 16, v149
v_and_b32 v115, s69, v149
v_lshlrev_b32 v116, 16, v150
v_and_b32 v117, s69, v150
v_lshlrev_b32 v118, 16, v151
v_and_b32 v119, s69, v151
s_lshl_b32 s76, s76, 16
v_mov_b32 v132, s76
v_pk_add_f32 v[122:123], v[112:113], v[132:133] op_sel_hi:[1,0] neg_lo:[0,1] neg_hi:[0,1]
v_pk_add_f32 v[124:125], v[114:115], v[132:133] op_sel_hi:[1,0] neg_lo:[0,1] neg_hi:[0,1]
v_pk_add_f32 v[126:127], v[116:117], v[132:133] op_sel_hi:[1,0] neg_lo:[0,1] neg_hi:[0,1]
v_pk_add_f32 v[128:129], v[118:119], v[132:133] op_sel_hi:[1,0] neg_lo:[0,1] neg_hi:[0,1]
v_pk_add_f32 v[120:121], v[122:123], v[124:125]
v_pk_mul_f32 v[130:131], v[122:123], v[122:123]
v_pk_add_f32 v[120:121], v[120:121], v[126:127]
v_pk_fma_f32 v[130:131], v[124:125], v[124:125], v[130:131]
v_pk_add_f32 v[120:121], v[120:121], v[128:129]
v_pk_fma_f32 v[130:131], v[126:127], v[126:127], v[130:131]
v_add_f32 v120, v120, v121
v_pk_fma_f32 v[130:131], v[128:129], v[128:129], v[130:131]
v_add_f32 v121, v130, v131
s_nop 1
v_permlane32_swap_b32 v120, v121
v_add_f32 v120, v120, v121
s_nop 1
v_add_f32_dpp v120, v120, v120 row_ror:8 row_mask:0xf bank_mask:0xf
s_nop 1
v_add_f32_dpp v120, v120, v120 row_ror:4 row_mask:0xf bank_mask:0xf
s_nop 1
v_add_f32_dpp v120, v120, v120 row_ror:2 row_mask:0xf bank_mask:0xf
s_nop 1
v_add_f32_dpp v120, v120, v120 row_ror:1 row_mask:0xf bank_mask:0xf
v_mov_b32 v121, v120
s_nop 1
v_permlane16_swap_b32 v120, v121
v_add_f32 v120, v120, v121
v_mul_f32 v120, 0x3b000000, v120
v_mov_b32 v121, v120
s_nop 1
v_permlane32_swap_b32 v120, v121
v_fma_f32 v121, -v120, v120, v121
v_add_f32 v120, v132, v120
v_max_f32 v121, 0, v121
v_cvt_pk_bf16_f32 v120, v120, v121
v_and_b32 v121, s69, v120
v_lshlrev_b32 v120, 16, v120
v_add_f32 v121, 0x3727c5ac, v121
v_pk_add_f32 v[112:113], v[112:113], v[120:121] op_sel_hi:[1,0] neg_lo:[0,1] neg_hi:[0,1]
v_cvt_pk_bf16_f32 v121, v121, v121
v_pk_add_f32 v[114:115], v[114:115], v[120:121] op_sel_hi:[1,0] neg_lo:[0,1] neg_hi:[0,1]
v_and_b32 v121, s69, v121
v_pk_add_f32 v[116:117], v[116:117], v[120:121] op_sel_hi:[1,0] neg_lo:[0,1] neg_hi:[0,1]
v_sqrt_f32 v121, v121
s_nop 0
v_pk_add_f32 v[118:119], v[118:119], v[120:121] op_sel_hi:[1,0] neg_lo:[0,1] neg_hi:[0,1]
v_cvt_pk_bf16_f32 v122, v112, v113
v_cvt_pk_bf16_f32 v121, v121, v121
v_cvt_pk_bf16_f32 v123, v114, v115
v_and_b32 v121, s69, v121
v_cvt_pk_bf16_f32 v124, v116, v117
v_rcp_f32 v132, v121
v_cvt_pk_bf16_f32 v125, v118, v119
v_lshlrev_b32 v112, 16, v122
v_and_b32 v113, s69, v122
v_lshlrev_b32 v114, 16, v123
v_and_b32 v115, s69, v123
v_lshlrev_b32 v116, 16, v124
v_and_b32 v117, s69, v124
v_lshlrev_b32 v118, 16, v125
v_and_b32 v119, s69, v125
v_pk_mul_f32 v[112:113], v[112:113], v[132:133] op_sel_hi:[1,0]
v_pk_mul_f32 v[114:115], v[114:115], v[132:133] op_sel_hi:[1,0]
v_pk_mul_f32 v[116:117], v[116:117], v[132:133] op_sel_hi:[1,0]
v_pk_mul_f32 v[118:119], v[118:119], v[132:133] op_sel_hi:[1,0]
v_cvt_pk_bf16_f32 v122, v112, v113
v_cvt_pk_bf16_f32 v123, v114, v115
v_cvt_pk_bf16_f32 v124, v116, v117
v_cvt_pk_bf16_f32 v125, v118, v119
v_lshlrev_b32 v112, 16, v122
v_and_b32 v113, s69, v122
v_lshlrev_b32 v114, 16, v123
v_and_b32 v115, s69, v123
v_lshlrev_b32 v116, 16, v124
v_and_b32 v117, s69, v124
v_lshlrev_b32 v118, 16, v125
v_and_b32 v119, s69, v125
v_pk_mul_f32 v[112:113], v[112:113], v[160:161]
v_pk_mul_f32 v[114:115], v[114:115], v[162:163]
v_pk_mul_f32 v[116:117], v[116:117], v[164:165]
v_pk_mul_f32 v[118:119], v[118:119], v[166:167]
v_cvt_pk_bf16_f32 v122, v112, v113
v_cvt_pk_bf16_f32 v123, v114, v115
v_cvt_pk_bf16_f32 v124, v116, v117
v_cvt_pk_bf16_f32 v125, v118, v119
v_lshlrev_b32 v112, 16, v122
v_and_b32 v113, s69, v122
v_lshlrev_b32 v114, 16, v123
v_and_b32 v115, s69, v123
v_lshlrev_b32 v116, 16, v124
v_and_b32 v117, s69, v124
v_lshlrev_b32 v118, 16, v125
v_and_b32 v119, s69, v125
v_pk_add_f32 v[112:113], v[112:113], v[168:169]
v_pk_add_f32 v[114:115], v[114:115], v[170:171]
v_pk_add_f32 v[116:117], v[116:117], v[172:173]
v_pk_add_f32 v[118:119], v[118:119], v[174:175]
v_cvt_pk_bf16_f32 v152, v112, v113
v_cvt_pk_bf16_f32 v153, v114, v115
v_cvt_pk_bf16_f32 v154, v116, v117
v_cvt_pk_bf16_f32 v155, v118, v119
ds_write_b128 v144, v[152:155]
v_and_b32 v181, 7, v1
v_mul_u32_u24 v181, 160, v181
v_lshrrev_b32 v182, 4, v1
v_lshl_add_u32 v181, v182, 3, v181
s_lshl_b32 s74, s3, 5
s_add_u32 s74, s74, 128768
v_add_u32 v181, s74, v181
s_waitcnt lgkmcnt(0)
s_barrier
s_cmp_ge_u32 s3, 4
s_cbranch_scc1 L_skip_21
ds_read_b128 v[112:115], v180 offset:0
ds_read_b128 v[116:119], v180 offset:64
ds_read_b128 v[120:123], v180 offset:128
ds_read_b128 v[124:127], v180 offset:192
ds_read_b128 v[128:131], v180 offset:256
ds_read_b128 v[132:135], v180 offset:320
ds_read_b128 v[136:139], v180 offset:384
ds_read_b128 v[140:143], v180 offset:448
ds_read_b128 v[144:147], v180 offset:512
ds_read_b128 v[148:151], v180 offset:576
ds_read_b128 v[152:155], v180 offset:640
ds_read_b128 v[156:159], v180 offset:704
ds_read_b128 v[160:163], v180 offset:768
ds_read_b128 v[164:167], v180 offset:832
ds_read_b128 v[168:171], v180 offset:896
ds_read_b128 v[172:175], v180 offset:960
s_waitcnt lgkmcnt(15)
v_mfma_f32_16x16x32_bf16 v[176:179], v[192:195], v[112:115], 0
s_waitcnt lgkmcnt(14)
v_mfma_f32_16x16x32_bf16 v[176:179], v[196:199], v[116:119], v[176:179]
s_waitcnt lgkmcnt(13)
v_mfma_f32_16x16x32_bf16 v[176:179], v[200:203], v[120:123], v[176:179]
s_waitcnt lgkmcnt(12)
v_mfma_f32_16x16x32_bf16 v[176:179], v[204:207], v[124:127], v[176:179]
s_waitcnt lgkmcnt(11)
v_mfma_f32_16x16x32_bf16 v[176:179], v[208:211], v[128:131], v[176:179]
s_waitcnt lgkmcnt(10)
v_mfma_f32_16x16x32_bf16 v[176:179], v[212:215], v[132:135], v[176:179]
s_waitcnt lgkmcnt(9)
v_mfma_f32_16x16x32_bf16 v[176:179], v[216:219], v[136:139], v[176:179]
s_waitcnt lgkmcnt(8)
v_mfma_f32_16x16x32_bf16 v[176:179], v[220:223], v[140:143], v[176:179]
s_waitcnt lgkmcnt(7)
v_mfma_f32_16x16x32_bf16 v[176:179], v[224:227], v[144:147], v[176:179]
s_waitcnt lgkmcnt(6)
v_mfma_f32_16x16x32_bf16 v[176:179], v[228:231], v[148:151], v[176:179]
s_waitcnt lgkmcnt(5)
v_mfma_f32_16x16x32_bf16 v[176:179], v[232:235], v[152:155], v[176:179]
s_waitcnt lgkmcnt(4)
v_mfma_f32_16x16x32_bf16 v[176:179], v[236:239], v[156:159], v[176:179]
s_waitcnt lgkmcnt(3)
v_mfma_f32_16x16x32_bf16 v[176:179], v[240:243], v[160:163], v[176:179]
s_waitcnt lgkmcnt(2)
v_mfma_f32_16x16x32_bf16 v[176:179], v[244:247], v[164:167], v[176:179]
s_waitcnt lgkmcnt(1)
v_mfma_f32_16x16x32_bf16 v[176:179], v[248:251], v[168:171], v[176:179]
s_waitcnt lgkmcnt(0)
v_mfma_f32_16x16x32_bf16 v[176:179], v[252:255], v[172:175], v[176:179]
s_nop 7
v_cvt_pk_bf16_f32 v168, v176, v177
v_cvt_pk_bf16_f32 v169, v178, v179
v_min_u32 v168, -2, v168
v_min_u32 v169, -2, v169
s_mov_b32 exec_lo, 0x00ff00ff
s_mov_b32 exec_hi, 0x00ff00ff
ds_write_b64 v181, v[168:169]
s_mov_b64 exec, -1
L_skip_21:
v_lshrrev_b32 v182, 3, v1
v_and_b32 v183, 7, v1
v_lshlrev_b32 v183, 4, v183
s_mov_b32 s74, 128768
v_mul_u32_u24 v181, 160, v182
v_add3_u32 v181, v181, v183, s74
v_lshl_add_u32 v182, v182, 13, v183
s_lshl_b32 s76, s87, 7
s_add_u32 s76, s76, 65536
s_waitcnt lgkmcnt(0)
s_barrier
s_cmp_lg_u32 s3, 0
s_cbranch_scc1 L_static_13
ds_read_b128 v[168:171], v181
s_waitcnt lgkmcnt(0)
buffer_store_dwordx4 v[168:171], v182, s[44:47], s76 offen sc1
s_branch L_static_13
L_plain_14:
s_cmp_eq_u32 s3, 0
s_cbranch_scc1 L_skip_22
s_barrier
L_skip_22:
L_static_13:
s_cmp_eq_u32 s3, 0
s_cbranch_scc1 L_svc_23
s_add_u32 s94, s89, 28672
s_and_b32 s94, s94, 0xfffff
s_add_u32 s94, s94, s88
buffer_load_dwordx4 v[96:99], v10, s[48:51], s94 offen offset:0 nt
s_waitcnt vmcnt(4)
buffer_load_dwordx4 v[100:103], v10, s[48:51], s94 offen offset:1024 nt
s_waitcnt vmcnt(4)
s_mov_b32 s56, s24
s_and_b32 s57, s25, 0xffff
s_mov_b32 s58, 0x400000
s_mov_b32 s59, 0x20000
v_lshrrev_b32 v12, 3, v1
v_lshlrev_b32 v12, 13, v12
v_and_b32 v13, 7, v1
v_lshl_add_u32 v12, v13, 4, v12
s_lshl_b32 s74, s42, 17
s_lshl_b32 s75, s43, 7
s_add_u32 s74, s74, s75
s_lshl_b32 s75, s3, 10
s_add_u32 s74, s74, s75
s_lshl_b32 s76, s3, 11
s_add_u32 s76, s76, 92160
s_add_u32 m0, s76, 0
s_add_u32 s75, s74, 0
buffer_load_dwordx4 v12, s[56:59], s75 offen nt lds
s_add_u32 m0, s76, 1024
s_add_u32 s75, s74, 65536
buffer_load_dwordx4 v12, s[56:59], s75 offen nt lds
s_cmp_lg_u32 s81, 3
s_cbranch_scc1 L_skip_25
s_cmp_ge_u32 s3, 4
s_cbranch_scc1 L_skip_26
s_lshl_b32 s7, s3, 13
s_add_u32 s7, s7, 0
s_mov_b32 s56, s30
s_and_b32 s57, s31, 0xffff
s_mov_b32 s58, 0x1c0000
s_mov_b32 s59, 0x20000
s_lshl_b32 s76, s82, 6
s_lshl_b32 s77, s3, 7
v_lshrrev_b32 v18, 3, v1
v_mul_u32_u24 v18, 1024, v18
v_and_b32 v19, 7, v1
v_lshl_add_u32 v18, v19, 4, v18
s_mul_i32 s74, s76, 1024
s_add_u32 s74, s74, s77
s_add_u32 m0, s7, 0
s_add_u32 s75, s74, 0
buffer_load_dwordx4 v18, s[56:59], s75 offen nt lds
s_add_u32 m0, s7, 1024
s_add_u32 s75, s74, 8192
buffer_load_dwordx4 v18, s[56:59], s75 offen nt lds
s_add_u32 m0, s7, 2048
s_add_u32 s75, s74, 16384
buffer_load_dwordx4 v18, s[56:59], s75 offen nt lds
s_add_u32 m0, s7, 3072
s_add_u32 s75, s74, 24576
buffer_load_dwordx4 v18, s[56:59], s75 offen nt lds
s_add_u32 m0, s7, 4096
s_add_u32 s75, s74, 32768
buffer_load_dwordx4 v18, s[56:59], s75 offen nt lds
s_add_u32 m0, s7, 5120
s_add_u32 s75, s74, 40960
buffer_load_dwordx4 v18, s[56:59], s75 offen nt lds
s_add_u32 m0, s7, 6144
s_add_u32 s75, s74, 49152
buffer_load_dwordx4 v18, s[56:59], s75 offen nt lds
s_add_u32 m0, s7, 7168
s_add_u32 s75, s74, 57344
buffer_load_dwordx4 v18, s[56:59], s75 offen nt lds
s_branch L_skip_25
L_skip_26:
s_mov_b32 s56, s28
s_and_b32 s57, s29, 0xffff
s_mov_b32 s58, 0x1c0000
s_mov_b32 s59, 0x20000
s_lshl_b32 s79, s82, 6
s_lshl_b32 s76, s3, 6
s_lshl_b32 s77, s79, 1
s_lshl_b32 s78, s3, 13
s_add_u32 s78, s78, 0
v_lshrrev_b32 v12, 3, v1
v_mul_u32_u24 v12, 3584, v12
v_and_b32 v13, 7, v1
v_lshl_add_u32 v12, v13, 4, v12
s_mul_i32 s74, s76, 3584
s_add_u32 s74, s74, s77
s_add_u32 m0, s78, 0
s_add_u32 s75, s74, 0
buffer_load_dwordx4 v12, s[56:59], s75 offen nt lds
s_add_u32 m0, s78, 1024
s_add_u32 s75, s74, 28672
buffer_load_dwordx4 v12, s[56:59], s75 offen nt lds
s_add_u32 m0, s78, 2048
s_add_u32 s75, s74, 57344
buffer_load_dwordx4 v12, s[56:59], s75 offen nt lds
s_add_u32 m0, s78, 3072
s_add_u32 s75, s74, 86016
buffer_load_dwordx4 v12, s[56:59], s75 offen nt lds
s_add_u32 m0, s78, 4096
s_add_u32 s75, s74, 114688
buffer_load_dwordx4 v12, s[56:59], s75 offen nt lds
s_add_u32 m0, s78, 5120
s_add_u32 s75, s74, 143360
buffer_load_dwordx4 v12, s[56:59], s75 offen nt lds
s_add_u32 m0, s78, 6144
s_add_u32 s75, s74, 172032
buffer_load_dwordx4 v12, s[56:59], s75 offen nt lds
s_add_u32 m0, s78, 7168
s_add_u32 s75, s74, 200704
buffer_load_dwordx4 v12, s[56:59], s75 offen nt lds
L_skip_25:
buffer_load_dwordx4 v[104:107], v10, s[48:51], s94 offen offset:2048 nt
s_waitcnt vmcnt(4)
buffer_load_dwordx4 v[108:111], v10, s[48:51], s94 offen offset:3072 nt
s_waitcnt vmcnt(4)
s_add_u32 s94, s89, 57344
s_and_b32 s94, s94, 0xfffff
s_add_u32 s94, s94, s88
buffer_load_dwordx4 v[112:115], v10, s[48:51], s94 offen offset:0 nt
s_waitcnt vmcnt(4)
buffer_load_dwordx4 v[116:119], v10, s[48:51], s94 offen offset:1024 nt
s_waitcnt vmcnt(4)
buffer_load_dwordx4 v[120:123], v10, s[48:51], s94 offen offset:2048 nt
s_waitcnt vmcnt(4)
buffer_load_dwordx4 v[124:127], v10, s[48:51], s94 offen offset:3072 nt
s_waitcnt vmcnt(4)
s_add_u32 s94, s89, 86016
s_and_b32 s94, s94, 0xfffff
s_add_u32 s94, s94, s88
buffer_load_dwordx4 v[128:131], v10, s[48:51], s94 offen offset:0 nt
s_waitcnt vmcnt(4)
buffer_load_dwordx4 v[132:135], v10, s[48:51], s94 offen offset:1024 nt
s_waitcnt vmcnt(4)
buffer_load_dwordx4 v[136:139], v10, s[48:51], s94 offen offset:2048 nt
s_waitcnt vmcnt(4)
buffer_load_dwordx4 v[140:143], v10, s[48:51], s94 offen offset:3072 nt
s_waitcnt vmcnt(4)
s_add_u32 s94, s89, 114688
s_and_b32 s94, s94, 0xfffff
s_add_u32 s94, s94, s88
buffer_load_dwordx4 v[208:211], v10, s[48:51], s94 offen offset:0 nt
s_waitcnt vmcnt(4)
buffer_load_dwordx4 v[212:215], v10, s[48:51], s94 offen offset:1024 nt
s_waitcnt vmcnt(4)
buffer_load_dwordx4 v[216:219], v10, s[48:51], s94 offen offset:2048 nt
s_waitcnt vmcnt(4)
buffer_load_dwordx4 v[220:223], v10, s[48:51], s94 offen offset:3072 nt
s_waitcnt vmcnt(4)
s_add_u32 s94, s89, 0
s_and_b32 s94, s94, 0xfffff
s_add_u32 s94, s94, s88
buffer_load_dwordx4 v[144:147], v11, s[52:55], s94 offen offset:0 nt
s_waitcnt vmcnt(4)
buffer_load_dwordx4 v[148:151], v11, s[52:55], s94 offen offset:1024 nt
s_waitcnt vmcnt(4)
v_mov_b32 v12, 130048
ds_write_b32 v12, v12 offset:12
buffer_load_dwordx4 v[152:155], v11, s[52:55], s94 offen offset:2048 nt
s_waitcnt vmcnt(4)
buffer_load_dwordx4 v[156:159], v11, s[52:55], s94 offen offset:3072 nt
s_waitcnt vmcnt(4)
s_add_u32 s94, s89, 28672
s_and_b32 s94, s94, 0xfffff
s_add_u32 s94, s94, s88
buffer_load_dwordx4 v[160:163], v11, s[52:55], s94 offen offset:0 nt
s_waitcnt vmcnt(4)
buffer_load_dwordx4 v[164:167], v11, s[52:55], s94 offen offset:1024 nt
s_waitcnt vmcnt(4)
buffer_load_dwordx4 v[168:171], v11, s[52:55], s94 offen offset:2048 nt
s_waitcnt vmcnt(4)
buffer_load_dwordx4 v[172:175], v11, s[52:55], s94 offen offset:3072 nt
s_waitcnt vmcnt(4)
s_add_u32 s94, s89, 57344
s_and_b32 s94, s94, 0xfffff
s_add_u32 s94, s94, s88
buffer_load_dwordx4 v[176:179], v11, s[52:55], s94 offen offset:0 nt
s_waitcnt vmcnt(4)
buffer_load_dwordx4 v[180:183], v11, s[52:55], s94 offen offset:1024 nt
s_waitcnt vmcnt(4)
buffer_load_dwordx4 v[184:187], v11, s[52:55], s94 offen offset:2048 nt
s_waitcnt vmcnt(4)
buffer_load_dwordx4 v[188:191], v11, s[52:55], s94 offen offset:3072 nt
s_waitcnt vmcnt(4)
s_add_u32 s94, s89, 86016
s_and_b32 s94, s94, 0xfffff
s_add_u32 s94, s94, s88
buffer_load_dwordx4 v[192:195], v11, s[52:55], s94 offen offset:0 nt
s_waitcnt vmcnt(4)
buffer_load_dwordx4 v[196:199], v11, s[52:55], s94 offen offset:1024 nt
s_waitcnt vmcnt(4)
buffer_load_dwordx4 v[200:203], v11, s[52:55], s94 offen offset:2048 nt
s_waitcnt vmcnt(4)
buffer_load_dwordx4 v[204:207], v11, s[52:55], s94 offen offset:3072 nt
s_waitcnt vmcnt(4)
s_add_u32 s94, s89, 114688
s_and_b32 s94, s94, 0xfffff
s_add_u32 s94, s94, s88
buffer_load_dwordx4 v[224:227], v11, s[52:55], s94 offen offset:0 nt
s_waitcnt vmcnt(4)
buffer_load_dwordx4 v[228:231], v11, s[52:55], s94 offen offset:1024 nt
s_waitcnt vmcnt(4)
buffer_load_dwordx4 v[232:235], v11, s[52:55], s94 offen offset:2048 nt
s_waitcnt vmcnt(4)
buffer_load_dwordx4 v[236:239], v11, s[52:55], s94 offen offset:3072 nt
v_mov_b32 v23, 130048
v_mov_b32 v46, 1
s_mov_b32 s13, 130112
L_lw_27:
ds_read_b32 v22, v23 offset:4
s_waitcnt lgkmcnt(0)
v_cmp_ne_u32 vcc, 0, v22
s_cbranch_vccnz L_lwok_28
s_sleep 1
s_sub_u32 s93, s93, 1
s_cbranch_scc1 L_end
s_branch L_lw_27
L_lwok_28:
v_readfirstlane_b32 s15, v22
v_and_b32 v12, 3, v1
v_lshlrev_b32 v12, 8, v12
v_lshrrev_b32 v13, 2, v1
v_lshl_add_u32 v12, v13, 4, v12
v_add_u32 v12, 131136, v12
ds_read_b128 v[4:7], v12
s_mov_b64 exec, 1
ds_add_rtn_u32 v22, v23, v46
s_mov_b64 exec, -1
s_cmp_lt_u32 s81, 3
s_cbranch_scc1 L_skip_29
s_mov_b32 s60, s16
s_and_b32 s61, s17, 0xffff
s_mov_b32 s62, 0x2000
s_mov_b32 s63, 0x20000
s_mul_i32 s74, s3, 6144
s_add_u32 s74, s74, 0
v_lshl_add_u32 v240, v1, 4, s74
s_mul_i32 s75, s82, 4
s_and_b32 s74, s3, 3
s_add_u32 s75, s75, s74
s_and_b32 s75, s75, 127
s_lshl_b32 s75, s75, 3
v_and_b32 v241, 7, v1
v_mul_u32_u24 v242, 6144, v241
v_add_u32 v242, s75, v242
v_lshl_add_u32 v241, v241, 10, s75
s_mov_b32 s98, 4096
s_mov_b32 s99, 5120
buffer_load_dwordx2 v[252:253], v241, s[60:63], 0 offen
buffer_load_dwordx4 v[244:247], v240, s[44:47], 0 offen offset:3072 sc1
buffer_load_dwordx4 v[248:251], v240, s[44:47], s98 offen sc1
buffer_load_dwordx2 v[40:41], v242, s[44:47], 0 offen offset:2048 sc1
buffer_load_dwordx2 v[42:43], v242, s[44:47], s99 offen sc1
L_skip_29:
s_waitcnt lgkmcnt(0)
v_lshl_add_u32 v45, v22, 2, s13
s_mov_b64 exec, 1
ds_read_b32 v22, v45
s_mov_b64 exec, -1
v_mfma_f32_16x16x32_bf16 v[28:31], v[80:83], v[4:7], 0
v_mfma_f32_16x16x32_bf16 v[80:83], v[84:87], v[4:7], 0
v_mfma_f32_16x16x32_bf16 v[84:87], v[88:91], v[4:7], 0
v_mfma_f32_16x16x32_bf16 v[88:91], v[92:95], v[4:7], 0
s_nop 4
v_mov_b32_dpp v24, v28 quad_perm:[0,1,2,3] row_mask:0xf bank_mask:0x1
v_mov_b32_dpp v25, v29 row_ror:12 row_mask:0xf bank_mask:0x1
v_mov_b32_dpp v26, v30 row_ror:8 row_mask:0xf bank_mask:0x1
v_mov_b32_dpp v27, v31 row_ror:4 row_mask:0xf bank_mask:0x1
v_mov_b32_dpp v24, v80 row_ror:4 row_mask:0xf bank_mask:0x2
v_mov_b32_dpp v25, v81 quad_perm:[0,1,2,3] row_mask:0xf bank_mask:0x2
v_mov_b32_dpp v26, v82 row_ror:12 row_mask:0xf bank_mask:0x2
v_mov_b32_dpp v27, v83 row_ror:8 row_mask:0xf bank_mask:0x2
v_mov_b32_dpp v24, v84 row_ror:8 row_mask:0xf bank_mask:0x4
v_mov_b32_dpp v25, v85 row_ror:4 row_mask:0xf bank_mask:0x4
v_mov_b32_dpp v26, v86 quad_perm:[0,1,2,3] row_mask:0xf bank_mask:0x4
v_mov_b32_dpp v27, v87 row_ror:12 row_mask:0xf bank_mask:0x4
v_mov_b32_dpp v24, v88 row_ror:12 row_mask:0xf bank_mask:0x8
v_mov_b32_dpp v25, v89 row_ror:8 row_mask:0xf bank_mask:0x8
v_mov_b32_dpp v26, v90 row_ror:4 row_mask:0xf bank_mask:0x8
v_mov_b32_dpp v27, v91 quad_perm:[0,1,2,3] row_mask:0xf bank_mask:0x8
v_add_f32 v24, v24, v25
v_add_f32 v26, v26, v27
v_add_f32 v12, v24, v26
v_cvt_pk_bf16_f32 v12, v12, v12
v_and_b32 v12, s69, v12
v_mul_f32 v12, s72, v12
v_cvt_pk_bf16_f32 v12, v12, v12
v_and_b32 v12, s69, v12
v_cmp_gt_f32 vcc, v12, v8
s_cbranch_vccz L_nomax_33
v_max_f32_dpp v13, v12, v12 row_ror:4 row_mask:0xf bank_mask:0xf
s_nop 1
v_max_f32_dpp v13, v13, v13 row_ror:8 row_mask:0xf bank_mask:0xf
v_mov_b32 v14, v13
s_nop 1
v_permlane16_swap_b32 v13, v14
v_max_f32 v13, v13, v14
v_mov_b32 v14, v13
s_nop 1
v_permlane32_swap_b32 v13, v14
v_max_f32 v13, v13, v14
v_max_f32 v13, v13, v8
v_sub_f32 v14, v8, v13
v_mov_b32 v8, v13
v_mul_f32 v14, s68, v14
v_exp_f32 v14, v14
s_nop 0
v_mul_f32 v9, v9, v14
v_mul_f32 v48, v48, v14
v_mul_f32 v49, v49, v14
v_mul_f32 v50, v50, v14
v_mul_f32 v51, v51, v14
v_mul_f32 v52, v52, v14
v_mul_f32 v53, v53, v14
v_mul_f32 v54, v54, v14
v_mul_f32 v55, v55, v14
v_mul_f32 v56, v56, v14
v_mul_f32 v57, v57, v14
v_mul_f32 v58, v58, v14
v_mul_f32 v59, v59, v14
v_mul_f32 v60, v60, v14
v_mul_f32 v61, v61, v14
v_mul_f32 v62, v62, v14
v_mul_f32 v63, v63, v14
v_mul_f32 v64, v64, v14
v_mul_f32 v65, v65, v14
v_mul_f32 v66, v66, v14
v_mul_f32 v67, v67, v14
v_mul_f32 v68, v68, v14
v_mul_f32 v69, v69, v14
v_mul_f32 v70, v70, v14
v_mul_f32 v71, v71, v14
v_mul_f32 v72, v72, v14
v_mul_f32 v73, v73, v14
v_mul_f32 v74, v74, v14
v_mul_f32 v75, v75, v14
v_mul_f32 v76, v76, v14
v_mul_f32 v77, v77, v14
v_mul_f32 v78, v78, v14
v_mul_f32 v79, v79, v14
L_nomax_33:
v_sub_f32 v12, v12, v8
v_mul_f32 v12, s68, v12
v_exp_f32 v12, v12
s_nop 1
v_mov_b32_dpp v13, v12 row_ror:12 row_mask:0xf bank_mask:0xf
v_add_f32 v9, v9, v12
v_cvt_pk_bf16_f32 v20, v12, v13
s_nop 1
v_mov_b32_dpp v21, v20 row_ror:8 row_mask:0xf bank_mask:0xf
v_perm_b32 v32, v148, v144, s70
v_perm_b32 v33, v156, v152, s70
v_perm_b32 v34, v148, v144, s71
v_perm_b32 v35, v156, v152, s71
v_mfma_f32_16x16x16_bf16 v[48:51], v[32:33], v[20:21], v[48:51]
v_perm_b32 v36, v149, v145, s70
v_perm_b32 v37, v157, v153, s70
v_mfma_f32_16x16x16_bf16 v[52:55], v[34:35], v[20:21], v[52:55]
v_perm_b32 v38, v149, v145, s71
v_perm_b32 v39, v157, v153, s71
v_mfma_f32_16x16x16_bf16 v[56:59], v[36:37], v[20:21], v[56:59]
v_perm_b32 v32, v150, v146, s70
v_perm_b32 v33, v158, v154, s70
v_mfma_f32_16x16x16_bf16 v[60:63], v[38:39], v[20:21], v[60:63]
v_perm_b32 v34, v150, v146, s71
v_perm_b32 v35, v158, v154, s71
v_mfma_f32_16x16x16_bf16 v[64:67], v[32:33], v[20:21], v[64:67]
v_perm_b32 v36, v151, v147, s70
v_perm_b32 v37, v159, v155, s70
v_mfma_f32_16x16x16_bf16 v[68:71], v[34:35], v[20:21], v[68:71]
v_perm_b32 v38, v151, v147, s71
v_perm_b32 v39, v159, v155, s71
v_mfma_f32_16x16x16_bf16 v[72:75], v[36:37], v[20:21], v[72:75]
s_nop 0
v_mfma_f32_16x16x16_bf16 v[76:79], v[38:39], v[20:21], v[76:79]
L_tk_34:
s_waitcnt lgkmcnt(0)
v_readfirstlane_b32 s94, v22
s_cmp_lg_u32 s94, -1
s_cbranch_scc1 L_tkok_35
s_mov_b64 exec, 1
ds_read_b32 v22, v45
s_mov_b64 exec, -1
s_sub_u32 s93, s93, 1
s_cbranch_scc1 L_end
s_branch L_tk_34
L_tkok_35:
s_cmp_ge_u32 s94, 116
s_cbranch_scc1 L_nodyn_32
s_lshl_b32 s94, s94, 12
s_add_u32 s94, s94, s73
s_add_u32 s94, s94, 573440
s_and_b32 s94, s94, 0xfffff
s_add_u32 s94, s94, s88
buffer_load_dwordx4 v[80:83], v10, s[48:51], s94 offen offset:0 nt
buffer_load_dwordx4 v[84:87], v10, s[48:51], s94 offen offset:1024 nt
buffer_load_dwordx4 v[88:91], v10, s[48:51], s94 offen offset:2048 nt
buffer_load_dwordx4 v[92:95], v10, s[48:51], s94 offen offset:3072 nt
v_mfma_f32_16x16x32_bf16 v[28:31], v[96:99], v[4:7], 0
v_mfma_f32_16x16x32_bf16 v[96:99], v[100:103], v[4:7], 0
v_mfma_f32_16x16x32_bf16 v[100:103], v[104:107], v[4:7], 0
v_mfma_f32_16x16x32_bf16 v[104:107], v[108:111], v[4:7], 0
s_nop 4
v_mov_b32_dpp v24, v28 quad_perm:[0,1,2,3] row_mask:0xf bank_mask:0x1
v_mov_b32_dpp v25, v29 row_ror:12 row_mask:0xf bank_mask:0x1
v_mov_b32_dpp v26, v30 row_ror:8 row_mask:0xf bank_mask:0x1
v_mov_b32_dpp v27, v31 row_ror:4 row_mask:0xf bank_mask:0x1
v_mov_b32_dpp v24, v96 row_ror:4 row_mask:0xf bank_mask:0x2
v_mov_b32_dpp v25, v97 quad_perm:[0,1,2,3] row_mask:0xf bank_mask:0x2
v_mov_b32_dpp v26, v98 row_ror:12 row_mask:0xf bank_mask:0x2
v_mov_b32_dpp v27, v99 row_ror:8 row_mask:0xf bank_mask:0x2
v_mov_b32_dpp v24, v100 row_ror:8 row_mask:0xf bank_mask:0x4
v_mov_b32_dpp v25, v101 row_ror:4 row_mask:0xf bank_mask:0x4
v_mov_b32_dpp v26, v102 quad_perm:[0,1,2,3] row_mask:0xf bank_mask:0x4
v_mov_b32_dpp v27, v103 row_ror:12 row_mask:0xf bank_mask:0x4
v_mov_b32_dpp v24, v104 row_ror:12 row_mask:0xf bank_mask:0x8
v_mov_b32_dpp v25, v105 row_ror:8 row_mask:0xf bank_mask:0x8
v_mov_b32_dpp v26, v106 row_ror:4 row_mask:0xf bank_mask:0x8
v_mov_b32_dpp v27, v107 quad_perm:[0,1,2,3] row_mask:0xf bank_mask:0x8
v_add_f32 v24, v24, v25
v_add_f32 v26, v26, v27
v_add_f32 v12, v24, v26
v_cvt_pk_bf16_f32 v12, v12, v12
v_and_b32 v12, s69, v12
v_mul_f32 v12, s72, v12
v_cvt_pk_bf16_f32 v12, v12, v12
v_and_b32 v12, s69, v12
v_cmp_gt_f32 vcc, v12, v8
s_cbranch_vccz L_nomax_36
v_max_f32_dpp v13, v12, v12 row_ror:4 row_mask:0xf bank_mask:0xf
s_nop 1
v_max_f32_dpp v13, v13, v13 row_ror:8 row_mask:0xf bank_mask:0xf
v_mov_b32 v14, v13
s_nop 1
v_permlane16_swap_b32 v13, v14
v_max_f32 v13, v13, v14
v_mov_b32 v14, v13
s_nop 1
v_permlane32_swap_b32 v13, v14
v_max_f32 v13, v13, v14
v_max_f32 v13, v13, v8
v_sub_f32 v14, v8, v13
v_mov_b32 v8, v13
v_mul_f32 v14, s68, v14
v_exp_f32 v14, v14
s_nop 0
v_mul_f32 v9, v9, v14
v_mul_f32 v48, v48, v14
v_mul_f32 v49, v49, v14
v_mul_f32 v50, v50, v14
v_mul_f32 v51, v51, v14
v_mul_f32 v52, v52, v14
v_mul_f32 v53, v53, v14
v_mul_f32 v54, v54, v14
v_mul_f32 v55, v55, v14
v_mul_f32 v56, v56, v14
v_mul_f32 v57, v57, v14
v_mul_f32 v58, v58, v14
v_mul_f32 v59, v59, v14
v_mul_f32 v60, v60, v14
v_mul_f32 v61, v61, v14
v_mul_f32 v62, v62, v14
v_mul_f32 v63, v63, v14
v_mul_f32 v64, v64, v14
v_mul_f32 v65, v65, v14
v_mul_f32 v66, v66, v14
v_mul_f32 v67, v67, v14
v_mul_f32 v68, v68, v14
v_mul_f32 v69, v69, v14
v_mul_f32 v70, v70, v14
v_mul_f32 v71, v71, v14
v_mul_f32 v72, v72, v14
v_mul_f32 v73, v73, v14
v_mul_f32 v74, v74, v14
v_mul_f32 v75, v75, v14
v_mul_f32 v76, v76, v14
v_mul_f32 v77, v77, v14
v_mul_f32 v78, v78, v14
v_mul_f32 v79, v79, v14
L_nomax_36:
v_sub_f32 v12, v12, v8
v_mul_f32 v12, s68, v12
v_exp_f32 v12, v12
s_nop 1
v_mov_b32_dpp v13, v12 row_ror:12 row_mask:0xf bank_mask:0xf
v_add_f32 v9, v9, v12
v_cvt_pk_bf16_f32 v20, v12, v13
s_nop 1
v_mov_b32_dpp v21, v20 row_ror:8 row_mask:0xf bank_mask:0xf
v_perm_b32 v32, v164, v160, s70
v_perm_b32 v33, v172, v168, s70
v_perm_b32 v34, v164, v160, s71
v_perm_b32 v35, v172, v168, s71
v_mfma_f32_16x16x16_bf16 v[48:51], v[32:33], v[20:21], v[48:51]
v_perm_b32 v36, v165, v161, s70
v_perm_b32 v37, v173, v169, s70
v_mfma_f32_16x16x16_bf16 v[52:55], v[34:35], v[20:21], v[52:55]
v_perm_b32 v38, v165, v161, s71
v_perm_b32 v39, v173, v169, s71
v_mfma_f32_16x16x16_bf16 v[56:59], v[36:37], v[20:21], v[56:59]
v_perm_b32 v32, v166, v162, s70
v_perm_b32 v33, v174, v170, s70
v_mfma_f32_16x16x16_bf16 v[60:63], v[38:39], v[20:21], v[60:63]
v_perm_b32 v34, v166, v162, s71
v_perm_b32 v35, v174, v170, s71
v_mfma_f32_16x16x16_bf16 v[64:67], v[32:33], v[20:21], v[64:67]
v_perm_b32 v36, v167, v163, s70
v_perm_b32 v37, v175, v171, s70
v_mfma_f32_16x16x16_bf16 v[68:71], v[34:35], v[20:21], v[68:71]
v_perm_b32 v38, v167, v163, s71
v_perm_b32 v39, v175, v171, s71
v_mfma_f32_16x16x16_bf16 v[72:75], v[36:37], v[20:21], v[72:75]
s_nop 0
v_mfma_f32_16x16x16_bf16 v[76:79], v[38:39], v[20:21], v[76:79]
buffer_load_dwordx4 v[144:147], v11, s[52:55], s94 offen offset:0 nt
buffer_load_dwordx4 v[148:151], v11, s[52:55], s94 offen offset:1024 nt
buffer_load_dwordx4 v[152:155], v11, s[52:55], s94 offen offset:2048 nt
buffer_load_dwordx4 v[156:159], v11, s[52:55], s94 offen offset:3072 nt
v_mfma_f32_16x16x32_bf16 v[28:31], v[112:115], v[4:7], 0
v_mfma_f32_16x16x32_bf16 v[112:115], v[116:119], v[4:7], 0
v_mfma_f32_16x16x32_bf16 v[116:119], v[120:123], v[4:7], 0
v_mfma_f32_16x16x32_bf16 v[120:123], v[124:127], v[4:7], 0
s_nop 4
v_mov_b32_dpp v24, v28 quad_perm:[0,1,2,3] row_mask:0xf bank_mask:0x1
v_mov_b32_dpp v25, v29 row_ror:12 row_mask:0xf bank_mask:0x1
v_mov_b32_dpp v26, v30 row_ror:8 row_mask:0xf bank_mask:0x1
v_mov_b32_dpp v27, v31 row_ror:4 row_mask:0xf bank_mask:0x1
v_mov_b32_dpp v24, v112 row_ror:4 row_mask:0xf bank_mask:0x2
v_mov_b32_dpp v25, v113 quad_perm:[0,1,2,3] row_mask:0xf bank_mask:0x2
v_mov_b32_dpp v26, v114 row_ror:12 row_mask:0xf bank_mask:0x2
v_mov_b32_dpp v27, v115 row_ror:8 row_mask:0xf bank_mask:0x2
v_mov_b32_dpp v24, v116 row_ror:8 row_mask:0xf bank_mask:0x4
v_mov_b32_dpp v25, v117 row_ror:4 row_mask:0xf bank_mask:0x4
v_mov_b32_dpp v26, v118 quad_perm:[0,1,2,3] row_mask:0xf bank_mask:0x4
v_mov_b32_dpp v27, v119 row_ror:12 row_mask:0xf bank_mask:0x4
v_mov_b32_dpp v24, v120 row_ror:12 row_mask:0xf bank_mask:0x8
v_mov_b32_dpp v25, v121 row_ror:8 row_mask:0xf bank_mask:0x8
v_mov_b32_dpp v26, v122 row_ror:4 row_mask:0xf bank_mask:0x8
v_mov_b32_dpp v27, v123 quad_perm:[0,1,2,3] row_mask:0xf bank_mask:0x8
v_add_f32 v24, v24, v25
v_add_f32 v26, v26, v27
v_add_f32 v12, v24, v26
v_cvt_pk_bf16_f32 v12, v12, v12
v_and_b32 v12, s69, v12
v_mul_f32 v12, s72, v12
v_cvt_pk_bf16_f32 v12, v12, v12
v_and_b32 v12, s69, v12
v_cmp_gt_f32 vcc, v12, v8
s_cbranch_vccz L_nomax_37
v_max_f32_dpp v13, v12, v12 row_ror:4 row_mask:0xf bank_mask:0xf
s_nop 1
v_max_f32_dpp v13, v13, v13 row_ror:8 row_mask:0xf bank_mask:0xf
v_mov_b32 v14, v13
s_nop 1
v_permlane16_swap_b32 v13, v14
v_max_f32 v13, v13, v14
v_mov_b32 v14, v13
s_nop 1
v_permlane32_swap_b32 v13, v14
v_max_f32 v13, v13, v14
v_max_f32 v13, v13, v8
v_sub_f32 v14, v8, v13
v_mov_b32 v8, v13
v_mul_f32 v14, s68, v14
v_exp_f32 v14, v14
s_nop 0
v_mul_f32 v9, v9, v14
v_mul_f32 v48, v48, v14
v_mul_f32 v49, v49, v14
v_mul_f32 v50, v50, v14
v_mul_f32 v51, v51, v14
v_mul_f32 v52, v52, v14
v_mul_f32 v53, v53, v14
v_mul_f32 v54, v54, v14
v_mul_f32 v55, v55, v14
v_mul_f32 v56, v56, v14
v_mul_f32 v57, v57, v14
v_mul_f32 v58, v58, v14
v_mul_f32 v59, v59, v14
v_mul_f32 v60, v60, v14
v_mul_f32 v61, v61, v14
v_mul_f32 v62, v62, v14
v_mul_f32 v63, v63, v14
v_mul_f32 v64, v64, v14
v_mul_f32 v65, v65, v14
v_mul_f32 v66, v66, v14
v_mul_f32 v67, v67, v14
v_mul_f32 v68, v68, v14
v_mul_f32 v69, v69, v14
v_mul_f32 v70, v70, v14
v_mul_f32 v71, v71, v14
v_mul_f32 v72, v72, v14
v_mul_f32 v73, v73, v14
v_mul_f32 v74, v74, v14
v_mul_f32 v75, v75, v14
v_mul_f32 v76, v76, v14
v_mul_f32 v77, v77, v14
v_mul_f32 v78, v78, v14
v_mul_f32 v79, v79, v14
L_nomax_37:
v_sub_f32 v12, v12, v8
v_mul_f32 v12, s68, v12
v_exp_f32 v12, v12
s_nop 1
v_mov_b32_dpp v13, v12 row_ror:12 row_mask:0xf bank_mask:0xf
v_add_f32 v9, v9, v12
v_cvt_pk_bf16_f32 v20, v12, v13
s_nop 1
v_mov_b32_dpp v21, v20 row_ror:8 row_mask:0xf bank_mask:0xf
v_perm_b32 v32, v180, v176, s70
v_perm_b32 v33, v188, v184, s70
v_perm_b32 v34, v180, v176, s71
v_perm_b32 v35, v188, v184, s71
v_mfma_f32_16x16x16_bf16 v[48:51], v[32:33], v[20:21], v[48:51]
v_perm_b32 v36, v181, v177, s70
v_perm_b32 v37, v189, v185, s70
v_mfma_f32_16x16x16_bf16 v[52:55], v[34:35], v[20:21], v[52:55]
v_perm_b32 v38, v181, v177, s71
v_perm_b32 v39, v189, v185, s71
v_mfma_f32_16x16x16_bf16 v[56:59], v[36:37], v[20:21], v[56:59]
v_perm_b32 v32, v182, v178, s70
v_perm_b32 v33, v190, v186, s70
v_mfma_f32_16x16x16_bf16 v[60:63], v[38:39], v[20:21], v[60:63]
v_perm_b32 v34, v182, v178, s71
v_perm_b32 v35, v190, v186, s71
v_mfma_f32_16x16x16_bf16 v[64:67], v[32:33], v[20:21], v[64:67]
v_perm_b32 v36, v183, v179, s70
v_perm_b32 v37, v191, v187, s70
v_mfma_f32_16x16x16_bf16 v[68:71], v[34:35], v[20:21], v[68:71]
v_perm_b32 v38, v183, v179, s71
v_perm_b32 v39, v191, v187, s71
v_mfma_f32_16x16x16_bf16 v[72:75], v[36:37], v[20:21], v[72:75]
s_nop 0
v_mfma_f32_16x16x16_bf16 v[76:79], v[38:39], v[20:21], v[76:79]
s_waitcnt vmcnt(12)
v_mfma_f32_16x16x32_bf16 v[28:31], v[128:131], v[4:7], 0
v_mfma_f32_16x16x32_bf16 v[128:131], v[132:135], v[4:7], 0
v_mfma_f32_16x16x32_bf16 v[132:135], v[136:139], v[4:7], 0
v_mfma_f32_16x16x32_bf16 v[136:139], v[140:143], v[4:7], 0
s_nop 4
v_mov_b32_dpp v24, v28 quad_perm:[0,1,2,3] row_mask:0xf bank_mask:0x1
v_mov_b32_dpp v25, v29 row_ror:12 row_mask:0xf bank_mask:0x1
v_mov_b32_dpp v26, v30 row_ror:8 row_mask:0xf bank_mask:0x1
v_mov_b32_dpp v27, v31 row_ror:4 row_mask:0xf bank_mask:0x1
v_mov_b32_dpp v24, v128 row_ror:4 row_mask:0xf bank_mask:0x2
v_mov_b32_dpp v25, v129 quad_perm:[0,1,2,3] row_mask:0xf bank_mask:0x2
v_mov_b32_dpp v26, v130 row_ror:12 row_mask:0xf bank_mask:0x2
v_mov_b32_dpp v27, v131 row_ror:8 row_mask:0xf bank_mask:0x2
v_mov_b32_dpp v24, v132 row_ror:8 row_mask:0xf bank_mask:0x4
v_mov_b32_dpp v25, v133 row_ror:4 row_mask:0xf bank_mask:0x4
v_mov_b32_dpp v26, v134 quad_perm:[0,1,2,3] row_mask:0xf bank_mask:0x4
v_mov_b32_dpp v27, v135 row_ror:12 row_mask:0xf bank_mask:0x4
v_mov_b32_dpp v24, v136 row_ror:12 row_mask:0xf bank_mask:0x8
v_mov_b32_dpp v25, v137 row_ror:8 row_mask:0xf bank_mask:0x8
v_mov_b32_dpp v26, v138 row_ror:4 row_mask:0xf bank_mask:0x8
v_mov_b32_dpp v27, v139 quad_perm:[0,1,2,3] row_mask:0xf bank_mask:0x8
v_add_f32 v24, v24, v25
v_add_f32 v26, v26, v27
v_add_f32 v12, v24, v26
v_cvt_pk_bf16_f32 v12, v12, v12
v_and_b32 v12, s69, v12
v_mul_f32 v12, s72, v12
v_cvt_pk_bf16_f32 v12, v12, v12
v_and_b32 v12, s69, v12
v_cmp_gt_f32 vcc, v12, v8
s_cbranch_vccz L_nomax_38
v_max_f32_dpp v13, v12, v12 row_ror:4 row_mask:0xf bank_mask:0xf
s_nop 1
v_max_f32_dpp v13, v13, v13 row_ror:8 row_mask:0xf bank_mask:0xf
v_mov_b32 v14, v13
s_nop 1
v_permlane16_swap_b32 v13, v14
v_max_f32 v13, v13, v14
v_mov_b32 v14, v13
s_nop 1
v_permlane32_swap_b32 v13, v14
v_max_f32 v13, v13, v14
v_max_f32 v13, v13, v8
v_sub_f32 v14, v8, v13
v_mov_b32 v8, v13
v_mul_f32 v14, s68, v14
v_exp_f32 v14, v14
s_nop 0
v_mul_f32 v9, v9, v14
v_mul_f32 v48, v48, v14
v_mul_f32 v49, v49, v14
v_mul_f32 v50, v50, v14
v_mul_f32 v51, v51, v14
v_mul_f32 v52, v52, v14
v_mul_f32 v53, v53, v14
v_mul_f32 v54, v54, v14
v_mul_f32 v55, v55, v14
v_mul_f32 v56, v56, v14
v_mul_f32 v57, v57, v14
v_mul_f32 v58, v58, v14
v_mul_f32 v59, v59, v14
v_mul_f32 v60, v60, v14
v_mul_f32 v61, v61, v14
v_mul_f32 v62, v62, v14
v_mul_f32 v63, v63, v14
v_mul_f32 v64, v64, v14
v_mul_f32 v65, v65, v14
v_mul_f32 v66, v66, v14
v_mul_f32 v67, v67, v14
v_mul_f32 v68, v68, v14
v_mul_f32 v69, v69, v14
v_mul_f32 v70, v70, v14
v_mul_f32 v71, v71, v14
v_mul_f32 v72, v72, v14
v_mul_f32 v73, v73, v14
v_mul_f32 v74, v74, v14
v_mul_f32 v75, v75, v14
v_mul_f32 v76, v76, v14
v_mul_f32 v77, v77, v14
v_mul_f32 v78, v78, v14
v_mul_f32 v79, v79, v14
L_nomax_38:
v_sub_f32 v12, v12, v8
v_mul_f32 v12, s68, v12
v_exp_f32 v12, v12
s_nop 1
v_mov_b32_dpp v13, v12 row_ror:12 row_mask:0xf bank_mask:0xf
v_add_f32 v9, v9, v12
v_cvt_pk_bf16_f32 v20, v12, v13
s_nop 1
v_mov_b32_dpp v21, v20 row_ror:8 row_mask:0xf bank_mask:0xf
v_perm_b32 v32, v196, v192, s70
v_perm_b32 v33, v204, v200, s70
v_perm_b32 v34, v196, v192, s71
v_perm_b32 v35, v204, v200, s71
v_mfma_f32_16x16x16_bf16 v[48:51], v[32:33], v[20:21], v[48:51]
v_perm_b32 v36, v197, v193, s70
v_perm_b32 v37, v205, v201, s70
v_mfma_f32_16x16x16_bf16 v[52:55], v[34:35], v[20:21], v[52:55]
v_perm_b32 v38, v197, v193, s71
v_perm_b32 v39, v205, v201, s71
v_mfma_f32_16x16x16_bf16 v[56:59], v[36:37], v[20:21], v[56:59]
v_perm_b32 v32, v198, v194, s70
v_perm_b32 v33, v206, v202, s70
v_mfma_f32_16x16x16_bf16 v[60:63], v[38:39], v[20:21], v[60:63]
v_perm_b32 v34, v198, v194, s71
v_perm_b32 v35, v206, v202, s71
v_mfma_f32_16x16x16_bf16 v[64:67], v[32:33], v[20:21], v[64:67]
v_perm_b32 v36, v199, v195, s70
v_perm_b32 v37, v207, v203, s70
v_mfma_f32_16x16x16_bf16 v[68:71], v[34:35], v[20:21], v[68:71]
v_perm_b32 v38, v199, v195, s71
v_perm_b32 v39, v207, v203, s71
v_mfma_f32_16x16x16_bf16 v[72:75], v[36:37], v[20:21], v[72:75]
s_nop 0
v_mfma_f32_16x16x16_bf16 v[76:79], v[38:39], v[20:21], v[76:79]
s_waitcnt vmcnt(8)
v_mfma_f32_16x16x32_bf16 v[28:31], v[208:211], v[4:7], 0
v_mfma_f32_16x16x32_bf16 v[208:211], v[212:215], v[4:7], 0
v_mfma_f32_16x16x32_bf16 v[212:215], v[216:219], v[4:7], 0
v_mfma_f32_16x16x32_bf16 v[216:219], v[220:223], v[4:7], 0
s_nop 4
v_mov_b32_dpp v24, v28 quad_perm:[0,1,2,3] row_mask:0xf bank_mask:0x1
v_mov_b32_dpp v25, v29 row_ror:12 row_mask:0xf bank_mask:0x1
v_mov_b32_dpp v26, v30 row_ror:8 row_mask:0xf bank_mask:0x1
v_mov_b32_dpp v27, v31 row_ror:4 row_mask:0xf bank_mask:0x1
v_mov_b32_dpp v24, v208 row_ror:4 row_mask:0xf bank_mask:0x2
v_mov_b32_dpp v25, v209 quad_perm:[0,1,2,3] row_mask:0xf bank_mask:0x2
v_mov_b32_dpp v26, v210 row_ror:12 row_mask:0xf bank_mask:0x2
v_mov_b32_dpp v27, v211 row_ror:8 row_mask:0xf bank_mask:0x2
v_mov_b32_dpp v24, v212 row_ror:8 row_mask:0xf bank_mask:0x4
v_mov_b32_dpp v25, v213 row_ror:4 row_mask:0xf bank_mask:0x4
v_mov_b32_dpp v26, v214 quad_perm:[0,1,2,3] row_mask:0xf bank_mask:0x4
v_mov_b32_dpp v27, v215 row_ror:12 row_mask:0xf bank_mask:0x4
v_mov_b32_dpp v24, v216 row_ror:12 row_mask:0xf bank_mask:0x8
v_mov_b32_dpp v25, v217 row_ror:8 row_mask:0xf bank_mask:0x8
v_mov_b32_dpp v26, v218 row_ror:4 row_mask:0xf bank_mask:0x8
v_mov_b32_dpp v27, v219 quad_perm:[0,1,2,3] row_mask:0xf bank_mask:0x8
v_add_f32 v24, v24, v25
v_add_f32 v26, v26, v27
v_add_f32 v12, v24, v26
v_cvt_pk_bf16_f32 v12, v12, v12
v_and_b32 v12, s69, v12
v_mul_f32 v12, s72, v12
v_cvt_pk_bf16_f32 v12, v12, v12
v_and_b32 v12, s69, v12
v_cmp_gt_f32 vcc, v12, v8
s_cbranch_vccz L_nomax_39
v_max_f32_dpp v13, v12, v12 row_ror:4 row_mask:0xf bank_mask:0xf
s_nop 1
v_max_f32_dpp v13, v13, v13 row_ror:8 row_mask:0xf bank_mask:0xf
v_mov_b32 v14, v13
s_nop 1
v_permlane16_swap_b32 v13, v14
v_max_f32 v13, v13, v14
v_mov_b32 v14, v13
s_nop 1
v_permlane32_swap_b32 v13, v14
v_max_f32 v13, v13, v14
v_max_f32 v13, v13, v8
v_sub_f32 v14, v8, v13
v_mov_b32 v8, v13
v_mul_f32 v14, s68, v14
v_exp_f32 v14, v14
s_nop 0
v_mul_f32 v9, v9, v14
v_mul_f32 v48, v48, v14
v_mul_f32 v49, v49, v14
v_mul_f32 v50, v50, v14
v_mul_f32 v51, v51, v14
v_mul_f32 v52, v52, v14
v_mul_f32 v53, v53, v14
v_mul_f32 v54, v54, v14
v_mul_f32 v55, v55, v14
v_mul_f32 v56, v56, v14
v_mul_f32 v57, v57, v14
v_mul_f32 v58, v58, v14
v_mul_f32 v59, v59, v14
v_mul_f32 v60, v60, v14
v_mul_f32 v61, v61, v14
v_mul_f32 v62, v62, v14
v_mul_f32 v63, v63, v14
v_mul_f32 v64, v64, v14
v_mul_f32 v65, v65, v14
v_mul_f32 v66, v66, v14
v_mul_f32 v67, v67, v14
v_mul_f32 v68, v68, v14
v_mul_f32 v69, v69, v14
v_mul_f32 v70, v70, v14
v_mul_f32 v71, v71, v14
v_mul_f32 v72, v72, v14
v_mul_f32 v73, v73, v14
v_mul_f32 v74, v74, v14
v_mul_f32 v75, v75, v14
v_mul_f32 v76, v76, v14
v_mul_f32 v77, v77, v14
v_mul_f32 v78, v78, v14
v_mul_f32 v79, v79, v14
L_nomax_39:
v_sub_f32 v12, v12, v8
v_mul_f32 v12, s68, v12
v_exp_f32 v12, v12
s_nop 1
v_mov_b32_dpp v13, v12 row_ror:12 row_mask:0xf bank_mask:0xf
v_add_f32 v9, v9, v12
v_cvt_pk_bf16_f32 v20, v12, v13
s_nop 1
v_mov_b32_dpp v21, v20 row_ror:8 row_mask:0xf bank_mask:0xf
v_perm_b32 v32, v228, v224, s70
v_perm_b32 v33, v236, v232, s70
v_perm_b32 v34, v228, v224, s71
v_perm_b32 v35, v236, v232, s71
v_mfma_f32_16x16x16_bf16 v[48:51], v[32:33], v[20:21], v[48:51]
v_perm_b32 v36, v229, v225, s70
v_perm_b32 v37, v237, v233, s70
v_mfma_f32_16x16x16_bf16 v[52:55], v[34:35], v[20:21], v[52:55]
v_perm_b32 v38, v229, v225, s71
v_perm_b32 v39, v237, v233, s71
v_mfma_f32_16x16x16_bf16 v[56:59], v[36:37], v[20:21], v[56:59]
v_perm_b32 v32, v230, v226, s70
v_perm_b32 v33, v238, v234, s70
v_mfma_f32_16x16x16_bf16 v[60:63], v[38:39], v[20:21], v[60:63]
v_perm_b32 v34, v230, v226, s71
v_perm_b32 v35, v238, v234, s71
v_mfma_f32_16x16x16_bf16 v[64:67], v[32:33], v[20:21], v[64:67]
v_perm_b32 v36, v231, v227, s70
v_perm_b32 v37, v239, v235, s70
v_mfma_f32_16x16x16_bf16 v[68:71], v[34:35], v[20:21], v[68:71]
v_perm_b32 v38, v231, v227, s71
v_perm_b32 v39, v239, v235, s71
v_mfma_f32_16x16x16_bf16 v[72:75], v[36:37], v[20:21], v[72:75]
s_nop 0
v_mfma_f32_16x16x16_bf16 v[76:79], v[38:39], v[20:21], v[76:79]
s_cmp_lt_u32 s81, 3
s_cbranch_scc1 L_skip_40
s_waitcnt vmcnt(8)
s_branch L_pollchk_43
L_poll_41:
buffer_load_dwordx4 v[244:247], v240, s[44:47], 0 offen offset:3072 sc1
buffer_load_dwordx4 v[248:251], v240, s[44:47], s98 offen sc1
buffer_load_dwordx2 v[40:41], v242, s[44:47], 0 offen offset:2048 sc1
buffer_load_dwordx2 v[42:43], v242, s[44:47], s99 offen sc1
s_waitcnt vmcnt(0)
L_pollchk_43:
v_max3_u32 v12, v244, v245, v246
v_max3_u32 v13, v247, v248, v249
v_max3_u32 v12, v12, v250, v251
v_max3_u32 v13, v13, v40, v41
v_max3_u32 v12, v12, v42, v43
v_max_u32 v12, v12, v13
v_cmp_eq_u32 vcc, -1, v12
s_cbranch_vccz L_pollok_42
s_sub_u32 s93, s93, 1
s_cbranch_scc1 L_end
s_branch L_poll_41
L_pollok_42:
s_cmp_lg_u32 s81, 3
s_cbranch_scc1 L_skip_44
v_lshlrev_b32 v160, 16, v248
v_and_b32 v161, s69, v248
v_lshlrev_b32 v162, 16, v249
v_and_b32 v163, s69, v249
v_lshlrev_b32 v164, 16, v250
v_and_b32 v165, s69, v250
v_lshlrev_b32 v166, 16, v251
v_and_b32 v167, s69, v251
v_add_f32 v160, 1.0, v160
v_add_f32 v161, 1.0, v161
v_add_f32 v162, 1.0, v162
v_add_f32 v163, 1.0, v163
v_add_f32 v164, 1.0, v164
v_add_f32 v165, 1.0, v165
v_add_f32 v166, 1.0, v166
v_add_f32 v167, 1.0, v167
v_cvt_pk_bf16_f32 v248, v160, v161
v_cvt_pk_bf16_f32 v249, v162, v163
v_cvt_pk_bf16_f32 v250, v164, v165
v_cvt_pk_bf16_f32 v251, v166, v167
v_lshlrev_b32 v160, 16, v248
v_and_b32 v161, s69, v248
v_lshlrev_b32 v162, 16, v249
v_and_b32 v163, s69, v249
v_lshlrev_b32 v164, 16, v250
v_and_b32 v165, s69, v250
v_lshlrev_b32 v166, 16, v251
v_and_b32 v167, s69, v251
v_lshlrev_b32 v168, 16, v244
v_and_b32 v169, s69, v244
v_lshlrev_b32 v170, 16, v245
v_and_b32 v171, s69, v245
v_lshlrev_b32 v172, 16, v246
v_and_b32 v173, s69, v246
v_lshlrev_b32 v174, 16, v247
v_and_b32 v175, s69, v247
s_cmp_ge_u32 s3, 4
s_cbranch_scc1 L_skip_44
s_lshl_b32 s78, s3, 13
s_add_u32 s78, s78, 0
v_lshrrev_b32 v12, 4, v1
v_lshlrev_b32 v12, 3, v12
v_bfe_u32 v13, v1, 2, 2
v_add_u32 v12, v12, v13
v_mul_u32_u24 v12, 128, v12
v_and_b32 v13, 3, v1
v_lshl_add_u32 v12, v13, 3, v12
v_add_u32 v12, s78, v12
ds_read_b64_tr_b16 v[112:113], v12 offset:0
ds_read_b64_tr_b16 v[114:115], v12 offset:512
ds_read_b64_tr_b16 v[116:117], v12 offset:32
ds_read_b64_tr_b16 v[118:119], v12 offset:544
ds_read_b64_tr_b16 v[120:121], v12 offset:64
ds_read_b64_tr_b16 v[122:123], v12 offset:576
ds_read_b64_tr_b16 v[124:125], v12 offset:96
ds_read_b64_tr_b16 v[126:127], v12 offset:608
ds_read_b64_tr_b16 v[128:129], v12 offset:4096
ds_read_b64_tr_b16 v[130:131], v12 offset:4608
ds_read_b64_tr_b16 v[132:133], v12 offset:4128
ds_read_b64_tr_b16 v[134:135], v12 offset:4640
ds_read_b64_tr_b16 v[136:137], v12 offset:4160
ds_read_b64_tr_b16 v[138:139], v12 offset:4672
ds_read_b64_tr_b16 v[140:141], v12 offset:4192
ds_read_b64_tr_b16 v[142:143], v12 offset:4704
s_waitcnt lgkmcnt(0)
s_mov_b32 s56, s28
s_and_b32 s57, s29, 0xffff
s_mov_b32 s58, 0x1c0000
s_mov_b32 s59, 0x20000
s_lshl_b32 s79, s82, 6
s_lshl_b32 s76, s3, 6
s_lshl_b32 s77, s79, 1
s_lshl_b32 s78, s3, 13
s_add_u32 s78, s78, 0
v_lshrrev_b32 v12, 3, v1
v_mul_u32_u24 v12, 3584, v12
v_and_b32 v13, 7, v1
v_lshl_add_u32 v12, v13, 4, v12
s_mul_i32 s74, s76, 3584
s_add_u32 s74, s74, s77
s_add_u32 m0, s78, 0
s_add_u32 s75, s74, 0
buffer_load_dwordx4 v12, s[56:59], s75 offen nt lds
s_add_u32 m0, s78, 1024
s_add_u32 s75, s74, 28672
buffer_load_dwordx4 v12, s[56:59], s75 offen nt lds
s_add_u32 m0, s78, 2048
s_add_u32 s75, s74, 57344
buffer_load_dwordx4 v12, s[56:59], s75 offen nt lds
s_add_u32 m0, s78, 3072
s_add_u32 s75, s74, 86016
buffer_load_dwordx4 v12, s[56:59], s75 offen nt lds
s_add_u32 m0, s78, 4096
s_add_u32 s75, s74, 114688
buffer_load_dwordx4 v12, s[56:59], s75 offen nt lds
s_add_u32 m0, s78, 5120
s_add_u32 s75, s74, 143360
buffer_load_dwordx4 v12, s[56:59], s75 offen nt lds
s_add_u32 m0, s78, 6144
s_add_u32 s75, s74, 172032
buffer_load_dwordx4 v12, s[56:59], s75 offen nt lds
s_add_u32 m0, s78, 7168
s_add_u32 s75, s74, 200704
buffer_load_dwordx4 v12, s[56:59], s75 offen nt lds
L_skip_44:
v_bfe_u32 v13, v1, 4, 1
v_lshlrev_b32 v13, 4, v13
v_cmp_lt_u32 vcc, 31, v1
s_nop 1
v_cndmask_b32 v188, v40, v41, vcc
v_lshrrev_b32 v188, v13, v188
v_lshlrev_b32 v188, 16, v188
v_cndmask_b32 v189, v42, v43, vcc
v_lshrrev_b32 v189, v13, v189
v_lshlrev_b32 v189, 16, v189
v_cndmask_b32 v190, v252, v253, vcc
v_lshrrev_b32 v190, v13, v190
v_lshlrev_b32 v190, 16, v190
L_skip_40:
s_lshl_b32 s7, s3, 13
s_add_u32 s7, s7, 0
s_add_u32 s74, s7, 91200
s_cmp_eq_u32 s3, 4
s_cselect_b32 s74, 74752, s74
s_cmp_ge_u32 s3, 4
s_cselect_b32 s7, s74, s7
v_and_b32 v12, 3, v1
v_lshrrev_b32 v13, 4, v1
v_mul_u32_u24 v176, 528, v12
v_lshl_add_u32 v176, v13, 4, v176
s_mul_i32 s74, s3, 2112
s_add_u32 s74, s74, 108544
v_add_u32 v176, s74, v176
s_lshl_b32 s74, s3, 2
s_add_u32 s74, s74, 125440
v_lshl_add_u32 v177, v12, 5, s74
s_lshr_b32 s75, s3, 1
s_and_b32 s76, s3, 1
s_mul_i32 s74, s75, 528
s_lshl_b32 s77, s76, 8
s_add_u32 s74, s74, s77
s_add_u32 s74, s74, 108544
v_lshl_add_u32 v178, v1, 2, s74
s_lshl_b32 s74, s75, 5
s_add_u32 s74, s74, 125440
v_mov_b32 v179, s74
v_lshlrev_b32 v180, 1, v1
s_and_b32 s74, s84, 7
s_lshl_b32 s74, s74, 2
s_add_u32 s74, s74, s75
s_lshl_b32 s4, s74, 13
s_lshl_b32 s79, s76, 12
s_add_u32 s4, s4, s79
s_lshl_b32 s78, s85, 10
s_lshr_b32 s79, s84, 3
s_lshl_b32 s79, s79, 7
s_add_u32 s79, s79, s78
s_add_u32 s4, s4, s79
s_add_u32 s4, s4, 655360
s_lshl_b32 s5, s74, 12
s_add_u32 s5, s5, s79
s_add_u32 s5, s5, 1966080
s_lshl_b32 s74, s42, 13
s_lshr_b32 s75, s3, 1
s_lshl_b32 s75, s75, 12
s_add_u32 s74, s74, s75
s_and_b32 s75, s3, 1
s_lshl_b32 s75, s75, 6
s_add_u32 s74, s74, s75
s_add_u32 s74, s74, 655360
v_lshrrev_b32 v181, 3, v1
v_lshlrev_b32 v181, 7, v181
v_and_b32 v14, 7, v1
v_lshl_add_u32 v181, v14, 3, v181
v_add_u32 v181, s74, v181
s_lshl_b32 s74, s42, 12
s_add_u32 s74, s74, 1966080
v_lshrrev_b32 v15, 3, v1
v_lshlrev_b32 v182, 7, v15
v_lshl_add_u32 v182, v12, 10, v182
v_add_u32 v182, s74, v182
s_mul_i32 s74, s3, 768
s_add_u32 s74, s74, 125696
v_mul_u32_u24 v183, 96, v15
v_and_b32 v14, 7, v1
v_lshl_add_u32 v183, v14, 3, v183
v_add_u32 v183, s74, v183
v_mul_u32_u24 v184, 96, v14
v_lshl_add_u32 v184, v13, 4, v184
v_add_u32 v184, 125696, v184
s_mul_i32 s75, s82, 4
s_and_b32 s74, s3, 3
s_add_u32 s75, s75, s74
s_and_b32 s75, s75, 127
s_lshl_b32 s74, s75, 11
s_add_u32 s74, s74, 917504
v_lshl_add_u32 v204, v1, 3, s74
s_lshl_b32 s74, s75, 11
s_add_u32 s74, s74, 1179648
v_lshl_add_u32 v205, v1, 3, s74
s_lshl_b32 s74, s75, 3
v_lshl_add_u32 v206, v14, 10, s74
v_and_b32 v14, 15, v1
v_lshlrev_b32 v185, 12, v13
v_lshl_add_u32 v185, v14, 4, v185
v_lshrrev_b32 v187, 1, v185
s_lshl_b32 s6, s43, 16
s_lshl_b32 s74, s3, 14
s_add_u32 s6, s6, s74
s_lshl_b32 s74, s42, 7
s_add_u32 s6, s6, s74
s_lshr_b32 s6, s6, 1
s_add_u32 s6, s6, 917504
s_lshl_b32 s78, s3, 5
s_add_u32 s78, s78, 92160
v_lshrrev_b32 v186, 4, v1
v_lshlrev_b32 v186, 3, v186
v_bfe_u32 v12, v1, 2, 2
v_add_u32 v186, v186, v12
v_mul_u32_u24 v186, 128, v186
v_and_b32 v12, 3, v1
v_lshl_add_u32 v186, v12, 3, v186
v_add_u32 v186, s78, v186
s_mov_b64 exec, 1
ds_add_rtn_u32 v22, v23, v46
s_mov_b64 exec, -1
s_waitcnt vmcnt(4)
s_waitcnt lgkmcnt(0)
v_lshl_add_u32 v45, v22, 2, s13
s_mov_b64 exec, 1
ds_read_b32 v22, v45
s_mov_b64 exec, -1
v_mfma_f32_16x16x32_bf16 v[28:31], v[80:83], v[4:7], 0
v_mfma_f32_16x16x32_bf16 v[80:83], v[84:87], v[4:7], 0
v_mfma_f32_16x16x32_bf16 v[84:87], v[88:91], v[4:7], 0
v_mfma_f32_16x16x32_bf16 v[88:91], v[92:95], v[4:7], 0
s_nop 4
v_mov_b32_dpp v24, v28 quad_perm:[0,1,2,3] row_mask:0xf bank_mask:0x1
v_mov_b32_dpp v25, v29 row_ror:12 row_mask:0xf bank_mask:0x1
v_mov_b32_dpp v26, v30 row_ror:8 row_mask:0xf bank_mask:0x1
v_mov_b32_dpp v27, v31 row_ror:4 row_mask:0xf bank_mask:0x1
v_mov_b32_dpp v24, v80 row_ror:4 row_mask:0xf bank_mask:0x2
v_mov_b32_dpp v25, v81 quad_perm:[0,1,2,3] row_mask:0xf bank_mask:0x2
v_mov_b32_dpp v26, v82 row_ror:12 row_mask:0xf bank_mask:0x2
v_mov_b32_dpp v27, v83 row_ror:8 row_mask:0xf bank_mask:0x2
v_mov_b32_dpp v24, v84 row_ror:8 row_mask:0xf bank_mask:0x4
v_mov_b32_dpp v25, v85 row_ror:4 row_mask:0xf bank_mask:0x4
v_mov_b32_dpp v26, v86 quad_perm:[0,1,2,3] row_mask:0xf bank_mask:0x4
v_mov_b32_dpp v27, v87 row_ror:12 row_mask:0xf bank_mask:0x4
v_mov_b32_dpp v24, v88 row_ror:12 row_mask:0xf bank_mask:0x8
v_mov_b32_dpp v25, v89 row_ror:8 row_mask:0xf bank_mask:0x8
v_mov_b32_dpp v26, v90 row_ror:4 row_mask:0xf bank_mask:0x8
v_mov_b32_dpp v27, v91 quad_perm:[0,1,2,3] row_mask:0xf bank_mask:0x8
v_add_f32 v24, v24, v25
v_add_f32 v26, v26, v27
v_add_f32 v12, v24, v26
v_cvt_pk_bf16_f32 v12, v12, v12
v_and_b32 v12, s69, v12
v_mul_f32 v12, s72, v12
v_cvt_pk_bf16_f32 v12, v12, v12
v_and_b32 v12, s69, v12
v_cmp_gt_f32 vcc, v12, v8
s_cbranch_vccz L_nomax_45
v_max_f32_dpp v13, v12, v12 row_ror:4 row_mask:0xf bank_mask:0xf
s_nop 1
v_max_f32_dpp v13, v13, v13 row_ror:8 row_mask:0xf bank_mask:0xf
v_mov_b32 v14, v13
s_nop 1
v_permlane16_swap_b32 v13, v14
v_max_f32 v13, v13, v14
v_mov_b32 v14, v13
s_nop 1
v_permlane32_swap_b32 v13, v14
v_max_f32 v13, v13, v14
v_max_f32 v13, v13, v8
v_sub_f32 v14, v8, v13
v_mov_b32 v8, v13
v_mul_f32 v14, s68, v14
v_exp_f32 v14, v14
s_nop 0
v_mul_f32 v9, v9, v14
v_mul_f32 v48, v48, v14
v_mul_f32 v49, v49, v14
v_mul_f32 v50, v50, v14
v_mul_f32 v51, v51, v14
v_mul_f32 v52, v52, v14
v_mul_f32 v53, v53, v14
v_mul_f32 v54, v54, v14
v_mul_f32 v55, v55, v14
v_mul_f32 v56, v56, v14
v_mul_f32 v57, v57, v14
v_mul_f32 v58, v58, v14
v_mul_f32 v59, v59, v14
v_mul_f32 v60, v60, v14
v_mul_f32 v61, v61, v14
v_mul_f32 v62, v62, v14
v_mul_f32 v63, v63, v14
v_mul_f32 v64, v64, v14
v_mul_f32 v65, v65, v14
v_mul_f32 v66, v66, v14
v_mul_f32 v67, v67, v14
v_mul_f32 v68, v68, v14
v_mul_f32 v69, v69, v14
v_mul_f32 v70, v70, v14
v_mul_f32 v71, v71, v14
v_mul_f32 v72, v72, v14
v_mul_f32 v73, v73, v14
v_mul_f32 v74, v74, v14
v_mul_f32 v75, v75, v14
v_mul_f32 v76, v76, v14
v_mul_f32 v77, v77, v14
v_mul_f32 v78, v78, v14
v_mul_f32 v79, v79, v14
L_nomax_45:
v_sub_f32 v12, v12, v8
v_mul_f32 v12, s68, v12
v_exp_f32 v12, v12
s_nop 1
v_mov_b32_dpp v13, v12 row_ror:12 row_mask:0xf bank_mask:0xf
v_add_f32 v9, v9, v12
v_cvt_pk_bf16_f32 v20, v12, v13
s_nop 1
v_mov_b32_dpp v21, v20 row_ror:8 row_mask:0xf bank_mask:0xf
L_loop_30:
L_tk_46:
s_waitcnt lgkmcnt(0)
v_readfirstlane_b32 s94, v22
s_cmp_lg_u32 s94, -1
s_cbranch_scc1 L_tkok_47
s_mov_b64 exec, 1
ds_read_b32 v22, v45
s_mov_b64 exec, -1
s_sub_u32 s93, s93, 1
s_cbranch_scc1 L_end
s_branch L_tk_46
L_tkok_47:
s_cmp_ge_u32 s94, 116
s_cbranch_scc1 L_last_31
s_lshl_b32 s94, s94, 12
s_add_u32 s94, s94, s73
s_add_u32 s94, s94, 573440
s_and_b32 s94, s94, 0xfffff
s_add_u32 s94, s94, s88
buffer_load_dwordx4 v[80:83], v10, s[48:51], s94 offen offset:0 nt
buffer_load_dwordx4 v[84:87], v10, s[48:51], s94 offen offset:1024 nt
buffer_load_dwordx4 v[88:91], v10, s[48:51], s94 offen offset:2048 nt
buffer_load_dwordx4 v[92:95], v10, s[48:51], s94 offen offset:3072 nt
s_waitcnt vmcnt(4)
v_perm_b32 v32, v148, v144, s70
v_perm_b32 v33, v156, v152, s70
v_perm_b32 v34, v148, v144, s71
v_perm_b32 v35, v156, v152, s71
v_mfma_f32_16x16x16_bf16 v[48:51], v[32:33], v[20:21], v[48:51]
v_perm_b32 v36, v149, v145, s70
v_perm_b32 v37, v157, v153, s70
v_mfma_f32_16x16x16_bf16 v[52:55], v[34:35], v[20:21], v[52:55]
v_perm_b32 v38, v149, v145, s71
v_perm_b32 v39, v157, v153, s71
v_mfma_f32_16x16x16_bf16 v[56:59], v[36:37], v[20:21], v[56:59]
v_perm_b32 v32, v150, v146, s70
v_perm_b32 v33, v158, v154, s70
v_mfma_f32_16x16x16_bf16 v[60:63], v[38:39], v[20:21], v[60:63]
v_perm_b32 v34, v150, v146, s71
v_perm_b32 v35, v158, v154, s71
v_mfma_f32_16x16x16_bf16 v[64:67], v[32:33], v[20:21], v[64:67]
v_perm_b32 v36, v151, v147, s70
v_perm_b32 v37, v159, v155, s70
v_mfma_f32_16x16x16_bf16 v[68:71], v[34:35], v[20:21], v[68:71]
v_perm_b32 v38, v151, v147, s71
v_perm_b32 v39, v159, v155, s71
v_mfma_f32_16x16x16_bf16 v[72:75], v[36:37], v[20:21], v[72:75]
s_nop 0
v_mfma_f32_16x16x16_bf16 v[76:79], v[38:39], v[20:21], v[76:79]
buffer_load_dwordx4 v[144:147], v11, s[52:55], s94 offen offset:0 nt
buffer_load_dwordx4 v[148:151], v11, s[52:55], s94 offen offset:1024 nt
buffer_load_dwordx4 v[152:155], v11, s[52:55], s94 offen offset:2048 nt
buffer_load_dwordx4 v[156:159], v11, s[52:55], s94 offen offset:3072 nt
s_mov_b64 exec, 1
ds_add_rtn_u32 v22, v23, v46
s_mov_b64 exec, -1
s_waitcnt lgkmcnt(0)
v_lshl_add_u32 v45, v22, 2, s13
s_mov_b64 exec, 1
ds_read_b32 v22, v45
s_mov_b64 exec, -1
s_waitcnt vmcnt(4)
v_mfma_f32_16x16x32_bf16 v[28:31], v[80:83], v[4:7], 0
v_mfma_f32_16x16x32_bf16 v[80:83], v[84:87], v[4:7], 0
v_mfma_f32_16x16x32_bf16 v[84:87], v[88:91], v[4:7], 0
v_mfma_f32_16x16x32_bf16 v[88:91], v[92:95], v[4:7], 0
s_nop 4
v_mov_b32_dpp v24, v28 quad_perm:[0,1,2,3] row_mask:0xf bank_mask:0x1
v_mov_b32_dpp v25, v29 row_ror:12 row_mask:0xf bank_mask:0x1
v_mov_b32_dpp v26, v30 row_ror:8 row_mask:0xf bank_mask:0x1
v_mov_b32_dpp v27, v31 row_ror:4 row_mask:0xf bank_mask:0x1
v_mov_b32_dpp v24, v80 row_ror:4 row_mask:0xf bank_mask:0x2
v_mov_b32_dpp v25, v81 quad_perm:[0,1,2,3] row_mask:0xf bank_mask:0x2
v_mov_b32_dpp v26, v82 row_ror:12 row_mask:0xf bank_mask:0x2
v_mov_b32_dpp v27, v83 row_ror:8 row_mask:0xf bank_mask:0x2
v_mov_b32_dpp v24, v84 row_ror:8 row_mask:0xf bank_mask:0x4
v_mov_b32_dpp v25, v85 row_ror:4 row_mask:0xf bank_mask:0x4
v_mov_b32_dpp v26, v86 quad_perm:[0,1,2,3] row_mask:0xf bank_mask:0x4
v_mov_b32_dpp v27, v87 row_ror:12 row_mask:0xf bank_mask:0x4
v_mov_b32_dpp v24, v88 row_ror:12 row_mask:0xf bank_mask:0x8
v_mov_b32_dpp v25, v89 row_ror:8 row_mask:0xf bank_mask:0x8
v_mov_b32_dpp v26, v90 row_ror:4 row_mask:0xf bank_mask:0x8
v_mov_b32_dpp v27, v91 quad_perm:[0,1,2,3] row_mask:0xf bank_mask:0x8
v_add_f32 v24, v24, v25
v_add_f32 v26, v26, v27
v_add_f32 v12, v24, v26
v_cvt_pk_bf16_f32 v12, v12, v12
v_and_b32 v12, s69, v12
v_mul_f32 v12, s72, v12
v_cvt_pk_bf16_f32 v12, v12, v12
v_and_b32 v12, s69, v12
v_cmp_gt_f32 vcc, v12, v8
s_cbranch_vccz L_nomax_48
v_max_f32_dpp v13, v12, v12 row_ror:4 row_mask:0xf bank_mask:0xf
s_nop 1
v_max_f32_dpp v13, v13, v13 row_ror:8 row_mask:0xf bank_mask:0xf
v_mov_b32 v14, v13
s_nop 1
v_permlane16_swap_b32 v13, v14
v_max_f32 v13, v13, v14
v_mov_b32 v14, v13
s_nop 1
v_permlane32_swap_b32 v13, v14
v_max_f32 v13, v13, v14
v_max_f32 v13, v13, v8
v_sub_f32 v14, v8, v13
v_mov_b32 v8, v13
v_mul_f32 v14, s68, v14
v_exp_f32 v14, v14
s_nop 0
v_mul_f32 v9, v9, v14
v_mul_f32 v48, v48, v14
v_mul_f32 v49, v49, v14
v_mul_f32 v50, v50, v14
v_mul_f32 v51, v51, v14
v_mul_f32 v52, v52, v14
v_mul_f32 v53, v53, v14
v_mul_f32 v54, v54, v14
v_mul_f32 v55, v55, v14
v_mul_f32 v56, v56, v14
v_mul_f32 v57, v57, v14
v_mul_f32 v58, v58, v14
v_mul_f32 v59, v59, v14
v_mul_f32 v60, v60, v14
v_mul_f32 v61, v61, v14
v_mul_f32 v62, v62, v14
v_mul_f32 v63, v63, v14
v_mul_f32 v64, v64, v14
v_mul_f32 v65, v65, v14
v_mul_f32 v66, v66, v14
v_mul_f32 v67, v67, v14
v_mul_f32 v68, v68, v14
v_mul_f32 v69, v69, v14
v_mul_f32 v70, v70, v14
v_mul_f32 v71, v71, v14
v_mul_f32 v72, v72, v14
v_mul_f32 v73, v73, v14
v_mul_f32 v74, v74, v14
v_mul_f32 v75, v75, v14
v_mul_f32 v76, v76, v14
v_mul_f32 v77, v77, v14
v_mul_f32 v78, v78, v14
v_mul_f32 v79, v79, v14
L_nomax_48:
v_sub_f32 v12, v12, v8
v_mul_f32 v12, s68, v12
v_exp_f32 v12, v12
s_nop 1
v_mov_b32_dpp v13, v12 row_ror:12 row_mask:0xf bank_mask:0xf
v_add_f32 v9, v9, v12
v_cvt_pk_bf16_f32 v20, v12, v13
s_nop 1
v_mov_b32_dpp v21, v20 row_ror:8 row_mask:0xf bank_mask:0xf
s_branch L_loop_30
L_nodyn_32:
v_mfma_f32_16x16x32_bf16 v[28:31], v[96:99], v[4:7], 0
v_mfma_f32_16x16x32_bf16 v[96:99], v[100:103], v[4:7], 0
v_mfma_f32_16x16x32_bf16 v[100:103], v[104:107], v[4:7], 0
v_mfma_f32_16x16x32_bf16 v[104:107], v[108:111], v[4:7], 0
s_nop 4
v_mov_b32_dpp v24, v28 quad_perm:[0,1,2,3] row_mask:0xf bank_mask:0x1
v_mov_b32_dpp v25, v29 row_ror:12 row_mask:0xf bank_mask:0x1
v_mov_b32_dpp v26, v30 row_ror:8 row_mask:0xf bank_mask:0x1
v_mov_b32_dpp v27, v31 row_ror:4 row_mask:0xf bank_mask:0x1
v_mov_b32_dpp v24, v96 row_ror:4 row_mask:0xf bank_mask:0x2
v_mov_b32_dpp v25, v97 quad_perm:[0,1,2,3] row_mask:0xf bank_mask:0x2
v_mov_b32_dpp v26, v98 row_ror:12 row_mask:0xf bank_mask:0x2
v_mov_b32_dpp v27, v99 row_ror:8 row_mask:0xf bank_mask:0x2
v_mov_b32_dpp v24, v100 row_ror:8 row_mask:0xf bank_mask:0x4
v_mov_b32_dpp v25, v101 row_ror:4 row_mask:0xf bank_mask:0x4
v_mov_b32_dpp v26, v102 quad_perm:[0,1,2,3] row_mask:0xf bank_mask:0x4
v_mov_b32_dpp v27, v103 row_ror:12 row_mask:0xf bank_mask:0x4
v_mov_b32_dpp v24, v104 row_ror:12 row_mask:0xf bank_mask:0x8
v_mov_b32_dpp v25, v105 row_ror:8 row_mask:0xf bank_mask:0x8
v_mov_b32_dpp v26, v106 row_ror:4 row_mask:0xf bank_mask:0x8
v_mov_b32_dpp v27, v107 quad_perm:[0,1,2,3] row_mask:0xf bank_mask:0x8
v_add_f32 v24, v24, v25
v_add_f32 v26, v26, v27
v_add_f32 v12, v24, v26
v_cvt_pk_bf16_f32 v12, v12, v12
v_and_b32 v12, s69, v12
v_mul_f32 v12, s72, v12
v_cvt_pk_bf16_f32 v12, v12, v12
v_and_b32 v12, s69, v12
v_cmp_gt_f32 vcc, v12, v8
s_cbranch_vccz L_nomax_49
v_max_f32_dpp v13, v12, v12 row_ror:4 row_mask:0xf bank_mask:0xf
s_nop 1
v_max_f32_dpp v13, v13, v13 row_ror:8 row_mask:0xf bank_mask:0xf
v_mov_b32 v14, v13
s_nop 1
v_permlane16_swap_b32 v13, v14
v_max_f32 v13, v13, v14
v_mov_b32 v14, v13
s_nop 1
v_permlane32_swap_b32 v13, v14
v_max_f32 v13, v13, v14
v_max_f32 v13, v13, v8
v_sub_f32 v14, v8, v13
v_mov_b32 v8, v13
v_mul_f32 v14, s68, v14
v_exp_f32 v14, v14
s_nop 0
v_mul_f32 v9, v9, v14
v_mul_f32 v48, v48, v14
v_mul_f32 v49, v49, v14
v_mul_f32 v50, v50, v14
v_mul_f32 v51, v51, v14
v_mul_f32 v52, v52, v14
v_mul_f32 v53, v53, v14
v_mul_f32 v54, v54, v14
v_mul_f32 v55, v55, v14
v_mul_f32 v56, v56, v14
v_mul_f32 v57, v57, v14
v_mul_f32 v58, v58, v14
v_mul_f32 v59, v59, v14
v_mul_f32 v60, v60, v14
v_mul_f32 v61, v61, v14
v_mul_f32 v62, v62, v14
v_mul_f32 v63, v63, v14
v_mul_f32 v64, v64, v14
v_mul_f32 v65, v65, v14
v_mul_f32 v66, v66, v14
v_mul_f32 v67, v67, v14
v_mul_f32 v68, v68, v14
v_mul_f32 v69, v69, v14
v_mul_f32 v70, v70, v14
v_mul_f32 v71, v71, v14
v_mul_f32 v72, v72, v14
v_mul_f32 v73, v73, v14
v_mul_f32 v74, v74, v14
v_mul_f32 v75, v75, v14
v_mul_f32 v76, v76, v14
v_mul_f32 v77, v77, v14
v_mul_f32 v78, v78, v14
v_mul_f32 v79, v79, v14
L_nomax_49:
v_sub_f32 v12, v12, v8
v_mul_f32 v12, s68, v12
v_exp_f32 v12, v12
s_nop 1
v_mov_b32_dpp v13, v12 row_ror:12 row_mask:0xf bank_mask:0xf
v_add_f32 v9, v9, v12
v_cvt_pk_bf16_f32 v20, v12, v13
s_nop 1
v_mov_b32_dpp v21, v20 row_ror:8 row_mask:0xf bank_mask:0xf
v_perm_b32 v32, v164, v160, s70
v_perm_b32 v33, v172, v168, s70
v_perm_b32 v34, v164, v160, s71
v_perm_b32 v35, v172, v168, s71
v_mfma_f32_16x16x16_bf16 v[48:51], v[32:33], v[20:21], v[48:51]
v_perm_b32 v36, v165, v161, s70
v_perm_b32 v37, v173, v169, s70
v_mfma_f32_16x16x16_bf16 v[52:55], v[34:35], v[20:21], v[52:55]
v_perm_b32 v38, v165, v161, s71
v_perm_b32 v39, v173, v169, s71
v_mfma_f32_16x16x16_bf16 v[56:59], v[36:37], v[20:21], v[56:59]
v_perm_b32 v32, v166, v162, s70
v_perm_b32 v33, v174, v170, s70
v_mfma_f32_16x16x16_bf16 v[60:63], v[38:39], v[20:21], v[60:63]
v_perm_b32 v34, v166, v162, s71
v_perm_b32 v35, v174, v170, s71
v_mfma_f32_16x16x16_bf16 v[64:67], v[32:33], v[20:21], v[64:67]
v_perm_b32 v36, v167, v163, s70
v_perm_b32 v37, v175, v171, s70
v_mfma_f32_16x16x16_bf16 v[68:71], v[34:35], v[20:21], v[68:71]
v_perm_b32 v38, v167, v163, s71
v_perm_b32 v39, v175, v171, s71
v_mfma_f32_16x16x16_bf16 v[72:75], v[36:37], v[20:21], v[72:75]
s_nop 0
v_mfma_f32_16x16x16_bf16 v[76:79], v[38:39], v[20:21], v[76:79]
v_mfma_f32_16x16x32_bf16 v[28:31], v[112:115], v[4:7], 0
v_mfma_f32_16x16x32_bf16 v[112:115], v[116:119], v[4:7], 0
v_mfma_f32_16x16x32_bf16 v[116:119], v[120:123], v[4:7], 0
v_mfma_f32_16x16x32_bf16 v[120:123], v[124:127], v[4:7], 0
s_nop 4
v_mov_b32_dpp v24, v28 quad_perm:[0,1,2,3] row_mask:0xf bank_mask:0x1
v_mov_b32_dpp v25, v29 row_ror:12 row_mask:0xf bank_mask:0x1
v_mov_b32_dpp v26, v30 row_ror:8 row_mask:0xf bank_mask:0x1
v_mov_b32_dpp v27, v31 row_ror:4 row_mask:0xf bank_mask:0x1
v_mov_b32_dpp v24, v112 row_ror:4 row_mask:0xf bank_mask:0x2
v_mov_b32_dpp v25, v113 quad_perm:[0,1,2,3] row_mask:0xf bank_mask:0x2
v_mov_b32_dpp v26, v114 row_ror:12 row_mask:0xf bank_mask:0x2
v_mov_b32_dpp v27, v115 row_ror:8 row_mask:0xf bank_mask:0x2
v_mov_b32_dpp v24, v116 row_ror:8 row_mask:0xf bank_mask:0x4
v_mov_b32_dpp v25, v117 row_ror:4 row_mask:0xf bank_mask:0x4
v_mov_b32_dpp v26, v118 quad_perm:[0,1,2,3] row_mask:0xf bank_mask:0x4
v_mov_b32_dpp v27, v119 row_ror:12 row_mask:0xf bank_mask:0x4
v_mov_b32_dpp v24, v120 row_ror:12 row_mask:0xf bank_mask:0x8
v_mov_b32_dpp v25, v121 row_ror:8 row_mask:0xf bank_mask:0x8
v_mov_b32_dpp v26, v122 row_ror:4 row_mask:0xf bank_mask:0x8
v_mov_b32_dpp v27, v123 quad_perm:[0,1,2,3] row_mask:0xf bank_mask:0x8
v_add_f32 v24, v24, v25
v_add_f32 v26, v26, v27
v_add_f32 v12, v24, v26
v_cvt_pk_bf16_f32 v12, v12, v12
v_and_b32 v12, s69, v12
v_mul_f32 v12, s72, v12
v_cvt_pk_bf16_f32 v12, v12, v12
v_and_b32 v12, s69, v12
v_cmp_gt_f32 vcc, v12, v8
s_cbranch_vccz L_nomax_50
v_max_f32_dpp v13, v12, v12 row_ror:4 row_mask:0xf bank_mask:0xf
s_nop 1
v_max_f32_dpp v13, v13, v13 row_ror:8 row_mask:0xf bank_mask:0xf
v_mov_b32 v14, v13
s_nop 1
v_permlane16_swap_b32 v13, v14
v_max_f32 v13, v13, v14
v_mov_b32 v14, v13
s_nop 1
v_permlane32_swap_b32 v13, v14
v_max_f32 v13, v13, v14
v_max_f32 v13, v13, v8
v_sub_f32 v14, v8, v13
v_mov_b32 v8, v13
v_mul_f32 v14, s68, v14
v_exp_f32 v14, v14
s_nop 0
v_mul_f32 v9, v9, v14
v_mul_f32 v48, v48, v14
v_mul_f32 v49, v49, v14
v_mul_f32 v50, v50, v14
v_mul_f32 v51, v51, v14
v_mul_f32 v52, v52, v14
v_mul_f32 v53, v53, v14
v_mul_f32 v54, v54, v14
v_mul_f32 v55, v55, v14
v_mul_f32 v56, v56, v14
v_mul_f32 v57, v57, v14
v_mul_f32 v58, v58, v14
v_mul_f32 v59, v59, v14
v_mul_f32 v60, v60, v14
v_mul_f32 v61, v61, v14
v_mul_f32 v62, v62, v14
v_mul_f32 v63, v63, v14
v_mul_f32 v64, v64, v14
v_mul_f32 v65, v65, v14
v_mul_f32 v66, v66, v14
v_mul_f32 v67, v67, v14
v_mul_f32 v68, v68, v14
v_mul_f32 v69, v69, v14
v_mul_f32 v70, v70, v14
v_mul_f32 v71, v71, v14
v_mul_f32 v72, v72, v14
v_mul_f32 v73, v73, v14
v_mul_f32 v74, v74, v14
v_mul_f32 v75, v75, v14
v_mul_f32 v76, v76, v14
v_mul_f32 v77, v77, v14
v_mul_f32 v78, v78, v14
v_mul_f32 v79, v79, v14
L_nomax_50:
v_sub_f32 v12, v12, v8
v_mul_f32 v12, s68, v12
v_exp_f32 v12, v12
s_nop 1
v_mov_b32_dpp v13, v12 row_ror:12 row_mask:0xf bank_mask:0xf
v_add_f32 v9, v9, v12
v_cvt_pk_bf16_f32 v20, v12, v13
s_nop 1
v_mov_b32_dpp v21, v20 row_ror:8 row_mask:0xf bank_mask:0xf
v_perm_b32 v32, v180, v176, s70
v_perm_b32 v33, v188, v184, s70
v_perm_b32 v34, v180, v176, s71
v_perm_b32 v35, v188, v184, s71
v_mfma_f32_16x16x16_bf16 v[48:51], v[32:33], v[20:21], v[48:51]
v_perm_b32 v36, v181, v177, s70
v_perm_b32 v37, v189, v185, s70
v_mfma_f32_16x16x16_bf16 v[52:55], v[34:35], v[20:21], v[52:55]
v_perm_b32 v38, v181, v177, s71
v_perm_b32 v39, v189, v185, s71
v_mfma_f32_16x16x16_bf16 v[56:59], v[36:37], v[20:21], v[56:59]
v_perm_b32 v32, v182, v178, s70
v_perm_b32 v33, v190, v186, s70
v_mfma_f32_16x16x16_bf16 v[60:63], v[38:39], v[20:21], v[60:63]
v_perm_b32 v34, v182, v178, s71
v_perm_b32 v35, v190, v186, s71
v_mfma_f32_16x16x16_bf16 v[64:67], v[32:33], v[20:21], v[64:67]
v_perm_b32 v36, v183, v179, s70
v_perm_b32 v37, v191, v187, s70
v_mfma_f32_16x16x16_bf16 v[68:71], v[34:35], v[20:21], v[68:71]
v_perm_b32 v38, v183, v179, s71
v_perm_b32 v39, v191, v187, s71
v_mfma_f32_16x16x16_bf16 v[72:75], v[36:37], v[20:21], v[72:75]
s_nop 0
v_mfma_f32_16x16x16_bf16 v[76:79], v[38:39], v[20:21], v[76:79]
s_waitcnt vmcnt(4)
v_mfma_f32_16x16x32_bf16 v[28:31], v[128:131], v[4:7], 0
v_mfma_f32_16x16x32_bf16 v[128:131], v[132:135], v[4:7], 0
v_mfma_f32_16x16x32_bf16 v[132:135], v[136:139], v[4:7], 0
v_mfma_f32_16x16x32_bf16 v[136:139], v[140:143], v[4:7], 0
s_nop 4
v_mov_b32_dpp v24, v28 quad_perm:[0,1,2,3] row_mask:0xf bank_mask:0x1
v_mov_b32_dpp v25, v29 row_ror:12 row_mask:0xf bank_mask:0x1
v_mov_b32_dpp v26, v30 row_ror:8 row_mask:0xf bank_mask:0x1
v_mov_b32_dpp v27, v31 row_ror:4 row_mask:0xf bank_mask:0x1
v_mov_b32_dpp v24, v128 row_ror:4 row_mask:0xf bank_mask:0x2
v_mov_b32_dpp v25, v129 quad_perm:[0,1,2,3] row_mask:0xf bank_mask:0x2
v_mov_b32_dpp v26, v130 row_ror:12 row_mask:0xf bank_mask:0x2
v_mov_b32_dpp v27, v131 row_ror:8 row_mask:0xf bank_mask:0x2
v_mov_b32_dpp v24, v132 row_ror:8 row_mask:0xf bank_mask:0x4
v_mov_b32_dpp v25, v133 row_ror:4 row_mask:0xf bank_mask:0x4
v_mov_b32_dpp v26, v134 quad_perm:[0,1,2,3] row_mask:0xf bank_mask:0x4
v_mov_b32_dpp v27, v135 row_ror:12 row_mask:0xf bank_mask:0x4
v_mov_b32_dpp v24, v136 row_ror:12 row_mask:0xf bank_mask:0x8
v_mov_b32_dpp v25, v137 row_ror:8 row_mask:0xf bank_mask:0x8
v_mov_b32_dpp v26, v138 row_ror:4 row_mask:0xf bank_mask:0x8
v_mov_b32_dpp v27, v139 quad_perm:[0,1,2,3] row_mask:0xf bank_mask:0x8
v_add_f32 v24, v24, v25
v_add_f32 v26, v26, v27
v_add_f32 v12, v24, v26
v_cvt_pk_bf16_f32 v12, v12, v12
v_and_b32 v12, s69, v12
v_mul_f32 v12, s72, v12
v_cvt_pk_bf16_f32 v12, v12, v12
v_and_b32 v12, s69, v12
v_cmp_gt_f32 vcc, v12, v8
s_cbranch_vccz L_nomax_51
v_max_f32_dpp v13, v12, v12 row_ror:4 row_mask:0xf bank_mask:0xf
s_nop 1
v_max_f32_dpp v13, v13, v13 row_ror:8 row_mask:0xf bank_mask:0xf
v_mov_b32 v14, v13
s_nop 1
v_permlane16_swap_b32 v13, v14
v_max_f32 v13, v13, v14
v_mov_b32 v14, v13
s_nop 1
v_permlane32_swap_b32 v13, v14
v_max_f32 v13, v13, v14
v_max_f32 v13, v13, v8
v_sub_f32 v14, v8, v13
v_mov_b32 v8, v13
v_mul_f32 v14, s68, v14
v_exp_f32 v14, v14
s_nop 0
v_mul_f32 v9, v9, v14
v_mul_f32 v48, v48, v14
v_mul_f32 v49, v49, v14
v_mul_f32 v50, v50, v14
v_mul_f32 v51, v51, v14
v_mul_f32 v52, v52, v14
v_mul_f32 v53, v53, v14
v_mul_f32 v54, v54, v14
v_mul_f32 v55, v55, v14
v_mul_f32 v56, v56, v14
v_mul_f32 v57, v57, v14
v_mul_f32 v58, v58, v14
v_mul_f32 v59, v59, v14
v_mul_f32 v60, v60, v14
v_mul_f32 v61, v61, v14
v_mul_f32 v62, v62, v14
v_mul_f32 v63, v63, v14
v_mul_f32 v64, v64, v14
v_mul_f32 v65, v65, v14
v_mul_f32 v66, v66, v14
v_mul_f32 v67, v67, v14
v_mul_f32 v68, v68, v14
v_mul_f32 v69, v69, v14
v_mul_f32 v70, v70, v14
v_mul_f32 v71, v71, v14
v_mul_f32 v72, v72, v14
v_mul_f32 v73, v73, v14
v_mul_f32 v74, v74, v14
v_mul_f32 v75, v75, v14
v_mul_f32 v76, v76, v14
v_mul_f32 v77, v77, v14
v_mul_f32 v78, v78, v14
v_mul_f32 v79, v79, v14
L_nomax_51:
v_sub_f32 v12, v12, v8
v_mul_f32 v12, s68, v12
v_exp_f32 v12, v12
s_nop 1
v_mov_b32_dpp v13, v12 row_ror:12 row_mask:0xf bank_mask:0xf
v_add_f32 v9, v9, v12
v_cvt_pk_bf16_f32 v20, v12, v13
s_nop 1
v_mov_b32_dpp v21, v20 row_ror:8 row_mask:0xf bank_mask:0xf
v_perm_b32 v32, v196, v192, s70
v_perm_b32 v33, v204, v200, s70
v_perm_b32 v34, v196, v192, s71
v_perm_b32 v35, v204, v200, s71
v_mfma_f32_16x16x16_bf16 v[48:51], v[32:33], v[20:21], v[48:51]
v_perm_b32 v36, v197, v193, s70
v_perm_b32 v37, v205, v201, s70
v_mfma_f32_16x16x16_bf16 v[52:55], v[34:35], v[20:21], v[52:55]
v_perm_b32 v38, v197, v193, s71
v_perm_b32 v39, v205, v201, s71
v_mfma_f32_16x16x16_bf16 v[56:59], v[36:37], v[20:21], v[56:59]
v_perm_b32 v32, v198, v194, s70
v_perm_b32 v33, v206, v202, s70
v_mfma_f32_16x16x16_bf16 v[60:63], v[38:39], v[20:21], v[60:63]
v_perm_b32 v34, v198, v194, s71
v_perm_b32 v35, v206, v202, s71
v_mfma_f32_16x16x16_bf16 v[64:67], v[32:33], v[20:21], v[64:67]
v_perm_b32 v36, v199, v195, s70
v_perm_b32 v37, v207, v203, s70
v_mfma_f32_16x16x16_bf16 v[68:71], v[34:35], v[20:21], v[68:71]
v_perm_b32 v38, v199, v195, s71
v_perm_b32 v39, v207, v203, s71
v_mfma_f32_16x16x16_bf16 v[72:75], v[36:37], v[20:21], v[72:75]
s_nop 0
v_mfma_f32_16x16x16_bf16 v[76:79], v[38:39], v[20:21], v[76:79]
s_waitcnt vmcnt(0)
v_mfma_f32_16x16x32_bf16 v[28:31], v[208:211], v[4:7], 0
v_mfma_f32_16x16x32_bf16 v[208:211], v[212:215], v[4:7], 0
v_mfma_f32_16x16x32_bf16 v[212:215], v[216:219], v[4:7], 0
v_mfma_f32_16x16x32_bf16 v[216:219], v[220:223], v[4:7], 0
s_nop 4
v_mov_b32_dpp v24, v28 quad_perm:[0,1,2,3] row_mask:0xf bank_mask:0x1
v_mov_b32_dpp v25, v29 row_ror:12 row_mask:0xf bank_mask:0x1
v_mov_b32_dpp v26, v30 row_ror:8 row_mask:0xf bank_mask:0x1
v_mov_b32_dpp v27, v31 row_ror:4 row_mask:0xf bank_mask:0x1
v_mov_b32_dpp v24, v208 row_ror:4 row_mask:0xf bank_mask:0x2
v_mov_b32_dpp v25, v209 quad_perm:[0,1,2,3] row_mask:0xf bank_mask:0x2
v_mov_b32_dpp v26, v210 row_ror:12 row_mask:0xf bank_mask:0x2
v_mov_b32_dpp v27, v211 row_ror:8 row_mask:0xf bank_mask:0x2
v_mov_b32_dpp v24, v212 row_ror:8 row_mask:0xf bank_mask:0x4
v_mov_b32_dpp v25, v213 row_ror:4 row_mask:0xf bank_mask:0x4
v_mov_b32_dpp v26, v214 quad_perm:[0,1,2,3] row_mask:0xf bank_mask:0x4
v_mov_b32_dpp v27, v215 row_ror:12 row_mask:0xf bank_mask:0x4
v_mov_b32_dpp v24, v216 row_ror:12 row_mask:0xf bank_mask:0x8
v_mov_b32_dpp v25, v217 row_ror:8 row_mask:0xf bank_mask:0x8
v_mov_b32_dpp v26, v218 row_ror:4 row_mask:0xf bank_mask:0x8
v_mov_b32_dpp v27, v219 quad_perm:[0,1,2,3] row_mask:0xf bank_mask:0x8
v_add_f32 v24, v24, v25
v_add_f32 v26, v26, v27
v_add_f32 v12, v24, v26
v_cvt_pk_bf16_f32 v12, v12, v12
v_and_b32 v12, s69, v12
v_mul_f32 v12, s72, v12
v_cvt_pk_bf16_f32 v12, v12, v12
v_and_b32 v12, s69, v12
v_cmp_gt_f32 vcc, v12, v8
s_cbranch_vccz L_nomax_52
v_max_f32_dpp v13, v12, v12 row_ror:4 row_mask:0xf bank_mask:0xf
s_nop 1
v_max_f32_dpp v13, v13, v13 row_ror:8 row_mask:0xf bank_mask:0xf
v_mov_b32 v14, v13
s_nop 1
v_permlane16_swap_b32 v13, v14
v_max_f32 v13, v13, v14
v_mov_b32 v14, v13
s_nop 1
v_permlane32_swap_b32 v13, v14
v_max_f32 v13, v13, v14
v_max_f32 v13, v13, v8
v_sub_f32 v14, v8, v13
v_mov_b32 v8, v13
v_mul_f32 v14, s68, v14
v_exp_f32 v14, v14
s_nop 0
v_mul_f32 v9, v9, v14
v_mul_f32 v48, v48, v14
v_mul_f32 v49, v49, v14
v_mul_f32 v50, v50, v14
v_mul_f32 v51, v51, v14
v_mul_f32 v52, v52, v14
v_mul_f32 v53, v53, v14
v_mul_f32 v54, v54, v14
v_mul_f32 v55, v55, v14
v_mul_f32 v56, v56, v14
v_mul_f32 v57, v57, v14
v_mul_f32 v58, v58, v14
v_mul_f32 v59, v59, v14
v_mul_f32 v60, v60, v14
v_mul_f32 v61, v61, v14
v_mul_f32 v62, v62, v14
v_mul_f32 v63, v63, v14
v_mul_f32 v64, v64, v14
v_mul_f32 v65, v65, v14
v_mul_f32 v66, v66, v14
v_mul_f32 v67, v67, v14
v_mul_f32 v68, v68, v14
v_mul_f32 v69, v69, v14
v_mul_f32 v70, v70, v14
v_mul_f32 v71, v71, v14
v_mul_f32 v72, v72, v14
v_mul_f32 v73, v73, v14
v_mul_f32 v74, v74, v14
v_mul_f32 v75, v75, v14
v_mul_f32 v76, v76, v14
v_mul_f32 v77, v77, v14
v_mul_f32 v78, v78, v14
v_mul_f32 v79, v79, v14
L_nomax_52:
v_sub_f32 v12, v12, v8
v_mul_f32 v12, s68, v12
v_exp_f32 v12, v12
s_nop 1
v_mov_b32_dpp v13, v12 row_ror:12 row_mask:0xf bank_mask:0xf
v_add_f32 v9, v9, v12
v_cvt_pk_bf16_f32 v20, v12, v13
s_nop 1
v_mov_b32_dpp v21, v20 row_ror:8 row_mask:0xf bank_mask:0xf
v_perm_b32 v32, v228, v224, s70
v_perm_b32 v33, v236, v232, s70
v_perm_b32 v34, v228, v224, s71
v_perm_b32 v35, v236, v232, s71
v_mfma_f32_16x16x16_bf16 v[48:51], v[32:33], v[20:21], v[48:51]
v_perm_b32 v36, v229, v225, s70
v_perm_b32 v37, v237, v233, s70
v_mfma_f32_16x16x16_bf16 v[52:55], v[34:35], v[20:21], v[52:55]
v_perm_b32 v38, v229, v225, s71
v_perm_b32 v39, v237, v233, s71
v_mfma_f32_16x16x16_bf16 v[56:59], v[36:37], v[20:21], v[56:59]
v_perm_b32 v32, v230, v226, s70
v_perm_b32 v33, v238, v234, s70
v_mfma_f32_16x16x16_bf16 v[60:63], v[38:39], v[20:21], v[60:63]
v_perm_b32 v34, v230, v226, s71
v_perm_b32 v35, v238, v234, s71
v_mfma_f32_16x16x16_bf16 v[64:67], v[32:33], v[20:21], v[64:67]
v_perm_b32 v36, v231, v227, s70
v_perm_b32 v37, v239, v235, s70
v_mfma_f32_16x16x16_bf16 v[68:71], v[34:35], v[20:21], v[68:71]
v_perm_b32 v38, v231, v227, s71
v_perm_b32 v39, v239, v235, s71
v_mfma_f32_16x16x16_bf16 v[72:75], v[36:37], v[20:21], v[72:75]
s_nop 0
v_mfma_f32_16x16x16_bf16 v[76:79], v[38:39], v[20:21], v[76:79]
s_cmp_lt_u32 s81, 3
s_cbranch_scc1 L_skip_53
s_waitcnt vmcnt(0)
s_branch L_pollchk_56
L_poll_54:
buffer_load_dwordx4 v[244:247], v240, s[44:47], 0 offen offset:3072 sc1
buffer_load_dwordx4 v[248:251], v240, s[44:47], s98 offen sc1
buffer_load_dwordx2 v[40:41], v242, s[44:47], 0 offen offset:2048 sc1
buffer_load_dwordx2 v[42:43], v242, s[44:47], s99 offen sc1
s_waitcnt vmcnt(0)
L_pollchk_56:
v_max3_u32 v12, v244, v245, v246
v_max3_u32 v13, v247, v248, v249
v_max3_u32 v12, v12, v250, v251
v_max3_u32 v13, v13, v40, v41
v_max3_u32 v12, v12, v42, v43
v_max_u32 v12, v12, v13
v_cmp_eq_u32 vcc, -1, v12
s_cbranch_vccz L_pollok_55
s_sub_u32 s93, s93, 1
s_cbranch_scc1 L_end
s_branch L_poll_54
L_pollok_55:
s_cmp_lg_u32 s81, 3
s_cbranch_scc1 L_skip_57
v_lshlrev_b32 v160, 16, v248
v_and_b32 v161, s69, v248
v_lshlrev_b32 v162, 16, v249
v_and_b32 v163, s69, v249
v_lshlrev_b32 v164, 16, v250
v_and_b32 v165, s69, v250
v_lshlrev_b32 v166, 16, v251
v_and_b32 v167, s69, v251
v_add_f32 v160, 1.0, v160
v_add_f32 v161, 1.0, v161
v_add_f32 v162, 1.0, v162
v_add_f32 v163, 1.0, v163
v_add_f32 v164, 1.0, v164
v_add_f32 v165, 1.0, v165
v_add_f32 v166, 1.0, v166
v_add_f32 v167, 1.0, v167
v_cvt_pk_bf16_f32 v248, v160, v161
v_cvt_pk_bf16_f32 v249, v162, v163
v_cvt_pk_bf16_f32 v250, v164, v165
v_cvt_pk_bf16_f32 v251, v166, v167
v_lshlrev_b32 v160, 16, v248
v_and_b32 v161, s69, v248
v_lshlrev_b32 v162, 16, v249
v_and_b32 v163, s69, v249
v_lshlrev_b32 v164, 16, v250
v_and_b32 v165, s69, v250
v_lshlrev_b32 v166, 16, v251
v_and_b32 v167, s69, v251
v_lshlrev_b32 v168, 16, v244
v_and_b32 v169, s69, v244
v_lshlrev_b32 v170, 16, v245
v_and_b32 v171, s69, v245
v_lshlrev_b32 v172, 16, v246
v_and_b32 v173, s69, v246
v_lshlrev_b32 v174, 16, v247
v_and_b32 v175, s69, v247
s_cmp_ge_u32 s3, 4
s_cbranch_scc1 L_skip_57
s_lshl_b32 s78, s3, 13
s_add_u32 s78, s78, 0
v_lshrrev_b32 v12, 4, v1
v_lshlrev_b32 v12, 3, v12
v_bfe_u32 v13, v1, 2, 2
v_add_u32 v12, v12, v13
v_mul_u32_u24 v12, 128, v12
v_and_b32 v13, 3, v1
v_lshl_add_u32 v12, v13, 3, v12
v_add_u32 v12, s78, v12
ds_read_b64_tr_b16 v[112:113], v12 offset:0
ds_read_b64_tr_b16 v[114:115], v12 offset:512
ds_read_b64_tr_b16 v[116:117], v12 offset:32
ds_read_b64_tr_b16 v[118:119], v12 offset:544
ds_read_b64_tr_b16 v[120:121], v12 offset:64
ds_read_b64_tr_b16 v[122:123], v12 offset:576
ds_read_b64_tr_b16 v[124:125], v12 offset:96
ds_read_b64_tr_b16 v[126:127], v12 offset:608
ds_read_b64_tr_b16 v[128:129], v12 offset:4096
ds_read_b64_tr_b16 v[130:131], v12 offset:4608
ds_read_b64_tr_b16 v[132:133], v12 offset:4128
ds_read_b64_tr_b16 v[134:135], v12 offset:4640
ds_read_b64_tr_b16 v[136:137], v12 offset:4160
ds_read_b64_tr_b16 v[138:139], v12 offset:4672
ds_read_b64_tr_b16 v[140:141], v12 offset:4192
ds_read_b64_tr_b16 v[142:143], v12 offset:4704
s_waitcnt lgkmcnt(0)
s_mov_b32 s56, s28
s_and_b32 s57, s29, 0xffff
s_mov_b32 s58, 0x1c0000
s_mov_b32 s59, 0x20000
s_lshl_b32 s79, s82, 6
s_lshl_b32 s76, s3, 6
s_lshl_b32 s77, s79, 1
s_lshl_b32 s78, s3, 13
s_add_u32 s78, s78, 0
v_lshrrev_b32 v12, 3, v1
v_mul_u32_u24 v12, 3584, v12
v_and_b32 v13, 7, v1
v_lshl_add_u32 v12, v13, 4, v12
s_mul_i32 s74, s76, 3584
s_add_u32 s74, s74, s77
s_add_u32 m0, s78, 0
s_add_u32 s75, s74, 0
buffer_load_dwordx4 v12, s[56:59], s75 offen nt lds
s_add_u32 m0, s78, 1024
s_add_u32 s75, s74, 28672
buffer_load_dwordx4 v12, s[56:59], s75 offen nt lds
s_add_u32 m0, s78, 2048
s_add_u32 s75, s74, 57344
buffer_load_dwordx4 v12, s[56:59], s75 offen nt lds
s_add_u32 m0, s78, 3072
s_add_u32 s75, s74, 86016
buffer_load_dwordx4 v12, s[56:59], s75 offen nt lds
s_add_u32 m0, s78, 4096
s_add_u32 s75, s74, 114688
buffer_load_dwordx4 v12, s[56:59], s75 offen nt lds
s_add_u32 m0, s78, 5120
s_add_u32 s75, s74, 143360
buffer_load_dwordx4 v12, s[56:59], s75 offen nt lds
s_add_u32 m0, s78, 6144
s_add_u32 s75, s74, 172032
buffer_load_dwordx4 v12, s[56:59], s75 offen nt lds
s_add_u32 m0, s78, 7168
s_add_u32 s75, s74, 200704
buffer_load_dwordx4 v12, s[56:59], s75 offen nt lds
L_skip_57:
v_bfe_u32 v13, v1, 4, 1
v_lshlrev_b32 v13, 4, v13
v_cmp_lt_u32 vcc, 31, v1
s_nop 1
v_cndmask_b32 v188, v40, v41, vcc
v_lshrrev_b32 v188, v13, v188
v_lshlrev_b32 v188, 16, v188
v_cndmask_b32 v189, v42, v43, vcc
v_lshrrev_b32 v189, v13, v189
v_lshlrev_b32 v189, 16, v189
v_cndmask_b32 v190, v252, v253, vcc
v_lshrrev_b32 v190, v13, v190
v_lshlrev_b32 v190, 16, v190
L_skip_53:
s_lshl_b32 s7, s3, 13
s_add_u32 s7, s7, 0
s_add_u32 s74, s7, 91200
s_cmp_eq_u32 s3, 4
s_cselect_b32 s74, 74752, s74
s_cmp_ge_u32 s3, 4
s_cselect_b32 s7, s74, s7
v_and_b32 v12, 3, v1
v_lshrrev_b32 v13, 4, v1
v_mul_u32_u24 v176, 528, v12
v_lshl_add_u32 v176, v13, 4, v176
s_mul_i32 s74, s3, 2112
s_add_u32 s74, s74, 108544
v_add_u32 v176, s74, v176
s_lshl_b32 s74, s3, 2
s_add_u32 s74, s74, 125440
v_lshl_add_u32 v177, v12, 5, s74
s_lshr_b32 s75, s3, 1
s_and_b32 s76, s3, 1
s_mul_i32 s74, s75, 528
s_lshl_b32 s77, s76, 8
s_add_u32 s74, s74, s77
s_add_u32 s74, s74, 108544
v_lshl_add_u32 v178, v1, 2, s74
s_lshl_b32 s74, s75, 5
s_add_u32 s74, s74, 125440
v_mov_b32 v179, s74
v_lshlrev_b32 v180, 1, v1
s_and_b32 s74, s84, 7
s_lshl_b32 s74, s74, 2
s_add_u32 s74, s74, s75
s_lshl_b32 s4, s74, 13
s_lshl_b32 s79, s76, 12
s_add_u32 s4, s4, s79
s_lshl_b32 s78, s85, 10
s_lshr_b32 s79, s84, 3
s_lshl_b32 s79, s79, 7
s_add_u32 s79, s79, s78
s_add_u32 s4, s4, s79
s_add_u32 s4, s4, 655360
s_lshl_b32 s5, s74, 12
s_add_u32 s5, s5, s79
s_add_u32 s5, s5, 1966080
s_lshl_b32 s74, s42, 13
s_lshr_b32 s75, s3, 1
s_lshl_b32 s75, s75, 12
s_add_u32 s74, s74, s75
s_and_b32 s75, s3, 1
s_lshl_b32 s75, s75, 6
s_add_u32 s74, s74, s75
s_add_u32 s74, s74, 655360
v_lshrrev_b32 v181, 3, v1
v_lshlrev_b32 v181, 7, v181
v_and_b32 v14, 7, v1
v_lshl_add_u32 v181, v14, 3, v181
v_add_u32 v181, s74, v181
s_lshl_b32 s74, s42, 12
s_add_u32 s74, s74, 1966080
v_lshrrev_b32 v15, 3, v1
v_lshlrev_b32 v182, 7, v15
v_lshl_add_u32 v182, v12, 10, v182
v_add_u32 v182, s74, v182
s_mul_i32 s74, s3, 768
s_add_u32 s74, s74, 125696
v_mul_u32_u24 v183, 96, v15
v_and_b32 v14, 7, v1
v_lshl_add_u32 v183, v14, 3, v183
v_add_u32 v183, s74, v183
v_mul_u32_u24 v184, 96, v14
v_lshl_add_u32 v184, v13, 4, v184
v_add_u32 v184, 125696, v184
s_mul_i32 s75, s82, 4
s_and_b32 s74, s3, 3
s_add_u32 s75, s75, s74
s_and_b32 s75, s75, 127
s_lshl_b32 s74, s75, 11
s_add_u32 s74, s74, 917504
v_lshl_add_u32 v204, v1, 3, s74
s_lshl_b32 s74, s75, 11
s_add_u32 s74, s74, 1179648
v_lshl_add_u32 v205, v1, 3, s74
s_lshl_b32 s74, s75, 3
v_lshl_add_u32 v206, v14, 10, s74
v_and_b32 v14, 15, v1
v_lshlrev_b32 v185, 12, v13
v_lshl_add_u32 v185, v14, 4, v185
v_lshrrev_b32 v187, 1, v185
s_lshl_b32 s6, s43, 16
s_lshl_b32 s74, s3, 14
s_add_u32 s6, s6, s74
s_lshl_b32 s74, s42, 7
s_add_u32 s6, s6, s74
s_lshr_b32 s6, s6, 1
s_add_u32 s6, s6, 917504
s_lshl_b32 s78, s3, 5
s_add_u32 s78, s78, 92160
v_lshrrev_b32 v186, 4, v1
v_lshlrev_b32 v186, 3, v186
v_bfe_u32 v12, v1, 2, 2
v_add_u32 v186, v186, v12
v_mul_u32_u24 v186, 128, v186
v_and_b32 v12, 3, v1
v_lshl_add_u32 v186, v12, 3, v186
v_add_u32 v186, s78, v186
s_waitcnt vmcnt(0)
s_mov_b32 s92, 0
s_branch L_streamend_24
L_svc_23:
s_mov_b32 s56, s24
s_and_b32 s57, s25, 0xffff
s_mov_b32 s58, 0x400000
s_mov_b32 s59, 0x20000
v_lshrrev_b32 v12, 3, v1
v_lshlrev_b32 v12, 13, v12
v_and_b32 v13, 7, v1
v_lshl_add_u32 v12, v13, 4, v12
s_lshl_b32 s74, s42, 17
s_lshl_b32 s75, s43, 7
s_add_u32 s74, s74, s75
s_lshl_b32 s75, s3, 10
s_add_u32 s74, s74, s75
s_lshl_b32 s76, s3, 11
s_add_u32 s76, s76, 92160
s_add_u32 m0, s76, 0
s_add_u32 s75, s74, 0
buffer_load_dwordx4 v12, s[56:59], s75 offen nt lds
s_add_u32 m0, s76, 1024
s_add_u32 s75, s74, 65536
buffer_load_dwordx4 v12, s[56:59], s75 offen nt lds
s_cmp_lg_u32 s81, 3
s_cbranch_scc1 L_skip_58
s_cmp_ge_u32 s3, 4
s_cbranch_scc1 L_skip_59
s_lshl_b32 s7, s3, 13
s_add_u32 s7, s7, 0
s_mov_b32 s56, s30
s_and_b32 s57, s31, 0xffff
s_mov_b32 s58, 0x1c0000
s_mov_b32 s59, 0x20000
s_lshl_b32 s76, s82, 6
s_lshl_b32 s77, s3, 7
v_lshrrev_b32 v18, 3, v1
v_mul_u32_u24 v18, 1024, v18
v_and_b32 v19, 7, v1
v_lshl_add_u32 v18, v19, 4, v18
s_mul_i32 s74, s76, 1024
s_add_u32 s74, s74, s77
s_add_u32 m0, s7, 0
s_add_u32 s75, s74, 0
buffer_load_dwordx4 v18, s[56:59], s75 offen nt lds
s_add_u32 m0, s7, 1024
s_add_u32 s75, s74, 8192
buffer_load_dwordx4 v18, s[56:59], s75 offen nt lds
s_add_u32 m0, s7, 2048
s_add_u32 s75, s74, 16384
buffer_load_dwordx4 v18, s[56:59], s75 offen nt lds
s_add_u32 m0, s7, 3072
s_add_u32 s75, s74, 24576
buffer_load_dwordx4 v18, s[56:59], s75 offen nt lds
s_add_u32 m0, s7, 4096
s_add_u32 s75, s74, 32768
buffer_load_dwordx4 v18, s[56:59], s75 offen nt lds
s_add_u32 m0, s7, 5120
s_add_u32 s75, s74, 40960
buffer_load_dwordx4 v18, s[56:59], s75 offen nt lds
s_add_u32 m0, s7, 6144
s_add_u32 s75, s74, 49152
buffer_load_dwordx4 v18, s[56:59], s75 offen nt lds
s_add_u32 m0, s7, 7168
s_add_u32 s75, s74, 57344
buffer_load_dwordx4 v18, s[56:59], s75 offen nt lds
s_branch L_skip_58
L_skip_59:
s_mov_b32 s56, s28
s_and_b32 s57, s29, 0xffff
s_mov_b32 s58, 0x1c0000
s_mov_b32 s59, 0x20000
s_lshl_b32 s79, s82, 6
s_lshl_b32 s76, s3, 6
s_lshl_b32 s77, s79, 1
s_lshl_b32 s78, s3, 13
s_add_u32 s78, s78, 0
v_lshrrev_b32 v12, 3, v1
v_mul_u32_u24 v12, 3584, v12
v_and_b32 v13, 7, v1
v_lshl_add_u32 v12, v13, 4, v12
s_mul_i32 s74, s76, 3584
s_add_u32 s74, s74, s77
s_add_u32 m0, s78, 0
s_add_u32 s75, s74, 0
buffer_load_dwordx4 v12, s[56:59], s75 offen nt lds
s_add_u32 m0, s78, 1024
s_add_u32 s75, s74, 28672
buffer_load_dwordx4 v12, s[56:59], s75 offen nt lds
s_add_u32 m0, s78, 2048
s_add_u32 s75, s74, 57344
buffer_load_dwordx4 v12, s[56:59], s75 offen nt lds
s_add_u32 m0, s78, 3072
s_add_u32 s75, s74, 86016
buffer_load_dwordx4 v12, s[56:59], s75 offen nt lds
s_add_u32 m0, s78, 4096
s_add_u32 s75, s74, 114688
buffer_load_dwordx4 v12, s[56:59], s75 offen nt lds
s_add_u32 m0, s78, 5120
s_add_u32 s75, s74, 143360
buffer_load_dwordx4 v12, s[56:59], s75 offen nt lds
s_add_u32 m0, s78, 6144
s_add_u32 s75, s74, 172032
buffer_load_dwordx4 v12, s[56:59], s75 offen nt lds
s_add_u32 m0, s78, 7168
s_add_u32 s75, s74, 200704
buffer_load_dwordx4 v12, s[56:59], s75 offen nt lds
L_skip_58:
s_lshl_b32 s7, s3, 13
s_add_u32 s7, s7, 0
s_add_u32 s74, s7, 91200
s_cmp_eq_u32 s3, 4
s_cselect_b32 s74, 74752, s74
s_cmp_ge_u32 s3, 4
s_cselect_b32 s7, s74, s7
v_and_b32 v12, 3, v1
v_lshrrev_b32 v13, 4, v1
v_mul_u32_u24 v176, 528, v12
v_lshl_add_u32 v176, v13, 4, v176
s_mul_i32 s74, s3, 2112
s_add_u32 s74, s74, 108544
v_add_u32 v176, s74, v176
s_lshl_b32 s74, s3, 2
s_add_u32 s74, s74, 125440
v_lshl_add_u32 v177, v12, 5, s74
s_lshr_b32 s75, s3, 1
s_and_b32 s76, s3, 1
s_mul_i32 s74, s75, 528
s_lshl_b32 s77, s76, 8
s_add_u32 s74, s74, s77
s_add_u32 s74, s74, 108544
v_lshl_add_u32 v178, v1, 2, s74
s_lshl_b32 s74, s75, 5
s_add_u32 s74, s74, 125440
v_mov_b32 v179, s74
v_lshlrev_b32 v180, 1, v1
s_and_b32 s74, s84, 7
s_lshl_b32 s74, s74, 2
s_add_u32 s74, s74, s75
s_lshl_b32 s4, s74, 13
s_lshl_b32 s79, s76, 12
s_add_u32 s4, s4, s79
s_lshl_b32 s78, s85, 10
s_lshr_b32 s79, s84, 3
s_lshl_b32 s79, s79, 7
s_add_u32 s79, s79, s78
s_add_u32 s4, s4, s79
s_add_u32 s4, s4, 655360
s_lshl_b32 s5, s74, 12
s_add_u32 s5, s5, s79
s_add_u32 s5, s5, 1966080
s_lshl_b32 s74, s42, 13
s_lshr_b32 s75, s3, 1
s_lshl_b32 s75, s75, 12
s_add_u32 s74, s74, s75
s_and_b32 s75, s3, 1
s_lshl_b32 s75, s75, 6
s_add_u32 s74, s74, s75
s_add_u32 s74, s74, 655360
v_lshrrev_b32 v181, 3, v1
v_lshlrev_b32 v181, 7, v181
v_and_b32 v14, 7, v1
v_lshl_add_u32 v181, v14, 3, v181
v_add_u32 v181, s74, v181
s_lshl_b32 s74, s42, 12
s_add_u32 s74, s74, 1966080
v_lshrrev_b32 v15, 3, v1
v_lshlrev_b32 v182, 7, v15
v_lshl_add_u32 v182, v12, 10, v182
v_add_u32 v182, s74, v182
s_mul_i32 s74, s3, 768
s_add_u32 s74, s74, 125696
v_mul_u32_u24 v183, 96, v15
v_and_b32 v14, 7, v1
v_lshl_add_u32 v183, v14, 3, v183
v_add_u32 v183, s74, v183
v_mul_u32_u24 v184, 96, v14
v_lshl_add_u32 v184, v13, 4, v184
v_add_u32 v184, 125696, v184
s_mul_i32 s75, s82, 4
s_and_b32 s74, s3, 3
s_add_u32 s75, s75, s74
s_and_b32 s75, s75, 127
s_lshl_b32 s74, s75, 11
s_add_u32 s74, s74, 917504
v_lshl_add_u32 v204, v1, 3, s74
s_lshl_b32 s74, s75, 11
s_add_u32 s74, s74, 1179648
v_lshl_add_u32 v205, v1, 3, s74
s_lshl_b32 s74, s75, 3
v_lshl_add_u32 v206, v14, 10, s74
v_and_b32 v14, 15, v1
v_lshlrev_b32 v185, 12, v13
v_lshl_add_u32 v185, v14, 4, v185
v_lshrrev_b32 v187, 1, v185
s_lshl_b32 s6, s43, 16
s_lshl_b32 s74, s3, 14
s_add_u32 s6, s6, s74
s_lshl_b32 s74, s42, 7
s_add_u32 s6, s6, s74
s_lshr_b32 s6, s6, 1
s_add_u32 s6, s6, 917504
s_lshl_b32 s78, s3, 5
s_add_u32 s78, s78, 92160
v_lshrrev_b32 v186, 4, v1
v_lshlrev_b32 v186, 3, v186
v_bfe_u32 v12, v1, 2, 2
v_add_u32 v186, v186, v12
v_mul_u32_u24 v186, 128, v186
v_and_b32 v12, 3, v1
v_lshl_add_u32 v186, v12, 3, v186
v_add_u32 v186, s78, v186
s_lshl_b32 s74, s84, 10
s_add_u32 s74, s74, 65536
v_lshl_add_u32 v45, v1, 4, s74
v_lshrrev_b32 v46, 2, v1
v_lshlrev_b32 v46, 12, v46
v_and_b32 v12, 3, v1
v_lshl_add_u32 v46, v12, 4, v46
v_add_u32 v46, 1839104, v46
s_mul_i32 s74, s84, 4096
s_add_u32 s74, s74, 3145728
v_mov_b32 v23, s74
v_mov_b32 v25, 130048
v_lshlrev_b32 v27, 2, v1
v_add_u32 v27, 130112, v27
L_lw_60:
ds_read_b32 v13, v25 offset:12
s_waitcnt lgkmcnt(0)
v_cmp_ne_u32 vcc, 0, v13
s_cbranch_vccnz L_lwok_61
s_sleep 2
s_sub_u32 s93, s93, 1
s_cbranch_scc1 L_end
s_branch L_lw_60
L_lwok_61:
L_wclr_62:
buffer_load_dwordx4 v[28:31], v46, s[44:47], 0 offen sc1
v_and_b32 v12, 31, v1
v_lshlrev_b32 v12, 2, v12
v_add_u32 v12, 1941504, v12
buffer_load_dword v26, v12, s[44:47], 0 offen sc1
s_waitcnt vmcnt(0)
v_xor_b32 v28, s80, v28
v_xor_b32 v29, s80, v29
v_xor_b32 v30, s80, v30
v_xor_b32 v31, s80, v31
v_or3_b32 v28, v28, v29, v30
v_or_b32 v28, v28, v31
v_xor_b32 v13, s80, v26
v_lshrrev_b32 v13, 4, v13
v_or_b32 v28, v28, v13
v_cmp_ne_u32 vcc, 0, v28
s_cbranch_vccz L_hclr_63
s_sub_u32 s93, s93, 1
s_cbranch_scc1 L_end
s_branch L_wclr_62
L_hclr_63:
v_readfirstlane_b32 s74, v26
s_nop 1
v_cmp_ne_u32 vcc, s74, v26
s_cmp_eq_u64 vcc, 0
s_cselect_b32 s15, 2, 1
v_mov_b32 v26, s15
v_mov_b32 v32, 8
s_mov_b64 exec, 1
buffer_atomic_add v32, v23, s[44:47], 0 offen sc0 sc1
s_mov_b64 exec, -1
buffer_load_dwordx4 v[4:7], v45, s[44:47], 0 offen sc1
s_cmp_lt_u32 s81, 3
s_cbranch_scc1 L_skip_64
s_mov_b32 s60, s16
s_and_b32 s61, s17, 0xffff
s_mov_b32 s62, 0x2000
s_mov_b32 s63, 0x20000
s_mul_i32 s74, s3, 6144
s_add_u32 s74, s74, 0
v_lshl_add_u32 v240, v1, 4, s74
s_mul_i32 s75, s82, 4
s_and_b32 s74, s3, 3
s_add_u32 s75, s75, s74
s_and_b32 s75, s75, 127
s_lshl_b32 s75, s75, 3
v_and_b32 v241, 7, v1
v_mul_u32_u24 v242, 6144, v241
v_add_u32 v242, s75, v242
v_lshl_add_u32 v241, v241, 10, s75
s_mov_b32 s98, 4096
s_mov_b32 s99, 5120
buffer_load_dwordx2 v[252:253], v241, s[60:63], 0 offen
buffer_load_dwordx4 v[244:247], v240, s[44:47], 0 offen offset:3072 sc1
buffer_load_dwordx4 v[248:251], v240, s[44:47], s98 offen sc1
buffer_load_dwordx2 v[40:41], v242, s[44:47], 0 offen offset:2048 sc1
buffer_load_dwordx2 v[42:43], v242, s[44:47], s99 offen sc1
L_skip_64:
s_waitcnt vmcnt(0)
s_branch L_pollchk_67
L_poll_65:
buffer_load_dwordx4 v[4:7], v45, s[44:47], 0 offen sc1
s_waitcnt vmcnt(0)
L_pollchk_67:
v_max3_u32 v12, v4, v5, v6
v_max_u32 v13, v7, v7
v_max_u32 v12, v12, v13
v_cmp_eq_u32 vcc, -1, v12
s_cbranch_vccz L_pollok_66
s_sub_u32 s93, s93, 1
s_cbranch_scc1 L_end
s_branch L_poll_65
L_pollok_66:
v_add_u32 v12, 131136, v11
ds_write_b128 v12, v[4:7]
v_readfirstlane_b32 s74, v32
s_nop 1
v_add_u32 v29, s74, v1
s_bfm_b64 exec, 8, 0
ds_write_b32 v27, v29
s_mov_b64 exec, -1
s_waitcnt lgkmcnt(0)
ds_write_b32 v25, v26 offset:4
s_cmp_lt_u32 s81, 3
s_cbranch_scc1 L_skip_68
s_waitcnt vmcnt(0)
s_branch L_pollchk_71
L_poll_69:
buffer_load_dwordx4 v[244:247], v240, s[44:47], 0 offen offset:3072 sc1
buffer_load_dwordx4 v[248:251], v240, s[44:47], s98 offen sc1
buffer_load_dwordx2 v[40:41], v242, s[44:47], 0 offen offset:2048 sc1
buffer_load_dwordx2 v[42:43], v242, s[44:47], s99 offen sc1
s_waitcnt vmcnt(0)
L_pollchk_71:
v_max3_u32 v12, v244, v245, v246
v_max3_u32 v13, v247, v248, v249
v_max3_u32 v12, v12, v250, v251
v_max3_u32 v13, v13, v40, v41
v_max3_u32 v12, v12, v42, v43
v_max_u32 v12, v12, v13
v_cmp_eq_u32 vcc, -1, v12
s_cbranch_vccz L_pollok_70
s_sub_u32 s93, s93, 1
s_cbranch_scc1 L_end
s_branch L_poll_69
L_pollok_70:
s_cmp_lg_u32 s81, 3
s_cbranch_scc1 L_skip_72
v_lshlrev_b32 v160, 16, v248
v_and_b32 v161, s69, v248
v_lshlrev_b32 v162, 16, v249
v_and_b32 v163, s69, v249
v_lshlrev_b32 v164, 16, v250
v_and_b32 v165, s69, v250
v_lshlrev_b32 v166, 16, v251
v_and_b32 v167, s69, v251
v_add_f32 v160, 1.0, v160
v_add_f32 v161, 1.0, v161
v_add_f32 v162, 1.0, v162
v_add_f32 v163, 1.0, v163
v_add_f32 v164, 1.0, v164
v_add_f32 v165, 1.0, v165
v_add_f32 v166, 1.0, v166
v_add_f32 v167, 1.0, v167
v_cvt_pk_bf16_f32 v248, v160, v161
v_cvt_pk_bf16_f32 v249, v162, v163
v_cvt_pk_bf16_f32 v250, v164, v165
v_cvt_pk_bf16_f32 v251, v166, v167
v_lshlrev_b32 v160, 16, v248
v_and_b32 v161, s69, v248
v_lshlrev_b32 v162, 16, v249
v_and_b32 v163, s69, v249
v_lshlrev_b32 v164, 16, v250
v_and_b32 v165, s69, v250
v_lshlrev_b32 v166, 16, v251
v_and_b32 v167, s69, v251
v_lshlrev_b32 v168, 16, v244
v_and_b32 v169, s69, v244
v_lshlrev_b32 v170, 16, v245
v_and_b32 v171, s69, v245
v_lshlrev_b32 v172, 16, v246
v_and_b32 v173, s69, v246
v_lshlrev_b32 v174, 16, v247
v_and_b32 v175, s69, v247
s_cmp_ge_u32 s3, 4
s_cbranch_scc1 L_skip_72
s_lshl_b32 s78, s3, 13
s_add_u32 s78, s78, 0
v_lshrrev_b32 v12, 4, v1
v_lshlrev_b32 v12, 3, v12
v_bfe_u32 v13, v1, 2, 2
v_add_u32 v12, v12, v13
v_mul_u32_u24 v12, 128, v12
v_and_b32 v13, 3, v1
v_lshl_add_u32 v12, v13, 3, v12
v_add_u32 v12, s78, v12
ds_read_b64_tr_b16 v[112:113], v12 offset:0
ds_read_b64_tr_b16 v[114:115], v12 offset:512
ds_read_b64_tr_b16 v[116:117], v12 offset:32
ds_read_b64_tr_b16 v[118:119], v12 offset:544
ds_read_b64_tr_b16 v[120:121], v12 offset:64
ds_read_b64_tr_b16 v[122:123], v12 offset:576
ds_read_b64_tr_b16 v[124:125], v12 offset:96
ds_read_b64_tr_b16 v[126:127], v12 offset:608
ds_read_b64_tr_b16 v[128:129], v12 offset:4096
ds_read_b64_tr_b16 v[130:131], v12 offset:4608
ds_read_b64_tr_b16 v[132:133], v12 offset:4128
ds_read_b64_tr_b16 v[134:135], v12 offset:4640
ds_read_b64_tr_b16 v[136:137], v12 offset:4160
ds_read_b64_tr_b16 v[138:139], v12 offset:4672
ds_read_b64_tr_b16 v[140:141], v12 offset:4192
ds_read_b64_tr_b16 v[142:143], v12 offset:4704
s_waitcnt lgkmcnt(0)
s_mov_b32 s56, s28
s_and_b32 s57, s29, 0xffff
s_mov_b32 s58, 0x1c0000
s_mov_b32 s59, 0x20000
s_lshl_b32 s79, s82, 6
s_lshl_b32 s76, s3, 6
s_lshl_b32 s77, s79, 1
s_lshl_b32 s78, s3, 13
s_add_u32 s78, s78, 0
v_lshrrev_b32 v12, 3, v1
v_mul_u32_u24 v12, 3584, v12
v_and_b32 v13, 7, v1
v_lshl_add_u32 v12, v13, 4, v12
s_mul_i32 s74, s76, 3584
s_add_u32 s74, s74, s77
s_add_u32 m0, s78, 0
s_add_u32 s75, s74, 0
buffer_load_dwordx4 v12, s[56:59], s75 offen nt lds
s_add_u32 m0, s78, 1024
s_add_u32 s75, s74, 28672
buffer_load_dwordx4 v12, s[56:59], s75 offen nt lds
s_add_u32 m0, s78, 2048
s_add_u32 s75, s74, 57344
buffer_load_dwordx4 v12, s[56:59], s75 offen nt lds
s_add_u32 m0, s78, 3072
s_add_u32 s75, s74, 86016
buffer_load_dwordx4 v12, s[56:59], s75 offen nt lds
s_add_u32 m0, s78, 4096
s_add_u32 s75, s74, 114688
buffer_load_dwordx4 v12, s[56:59], s75 offen nt lds
s_add_u32 m0, s78, 5120
s_add_u32 s75, s74, 143360
buffer_load_dwordx4 v12, s[56:59], s75 offen nt lds
s_add_u32 m0, s78, 6144
s_add_u32 s75, s74, 172032
buffer_load_dwordx4 v12, s[56:59], s75 offen nt lds
s_add_u32 m0, s78, 7168
s_add_u32 s75, s74, 200704
buffer_load_dwordx4 v12, s[56:59], s75 offen nt lds
L_skip_72:
v_bfe_u32 v13, v1, 4, 1
v_lshlrev_b32 v13, 4, v13
v_cmp_lt_u32 vcc, 31, v1
s_nop 1
v_cndmask_b32 v188, v40, v41, vcc
v_lshrrev_b32 v188, v13, v188
v_lshlrev_b32 v188, 16, v188
v_cndmask_b32 v189, v42, v43, vcc
v_lshrrev_b32 v189, v13, v189
v_lshlrev_b32 v189, 16, v189
v_cndmask_b32 v190, v252, v253, vcc
v_lshrrev_b32 v190, v13, v190
v_lshlrev_b32 v190, 16, v190
L_skip_68:
s_mov_b32 s14, 0
s_mov_b32 s101, 8
s_mov_b32 s16, 8
s_mov_b32 s17, 0
s_mov_b32 s18, 0
s_mov_b32 s19, 0
L_sl_73:
ds_read_b32 v28, v25
s_waitcnt vmcnt(3)
s_cmp_eq_u32 s16, 0
s_cbranch_scc1 L_skip_75
v_readfirstlane_b32 s74, v32
s_nop 1
v_add_u32 v29, s74, v1
v_add_u32 v30, s14, v27
s_add_u32 s75, s74, s16
s_cmp_ge_u32 s75, 116
s_cbranch_scc1 L_sdone_74
s_bfm_b64 exec, s16, 0
ds_write_b32 v30, v29
s_mov_b64 exec, -1
s_lshl_b32 s74, s16, 2
s_add_u32 s14, s14, s74
L_skip_75:
s_waitcnt lgkmcnt(0)
v_readfirstlane_b32 s74, v28
s_add_u32 s74, s74, 8
s_sub_u32 s16, s74, s101
s_cmp_lt_u32 s16, 4
s_cselect_b32 s16, 0, s16
s_cselect_b32 s74, 0x7ffffff0, 0
s_add_u32 s101, s101, s16
v_mov_b32 v32, s16
s_mov_b64 exec, 1
buffer_atomic_add v32, v23, s[44:47], s74 offen sc0 sc1
s_mov_b64 exec, -1
s_sleep 8
ds_read_b32 v28, v25
s_waitcnt vmcnt(3)
s_cmp_eq_u32 s17, 0
s_cbranch_scc1 L_skip_76
v_readfirstlane_b32 s74, v33
s_nop 1
v_add_u32 v29, s74, v1
v_add_u32 v30, s14, v27
s_add_u32 s75, s74, s17
s_cmp_ge_u32 s75, 116
s_cbranch_scc1 L_sdone_74
s_bfm_b64 exec, s17, 0
ds_write_b32 v30, v29
s_mov_b64 exec, -1
s_lshl_b32 s74, s17, 2
s_add_u32 s14, s14, s74
L_skip_76:
s_waitcnt lgkmcnt(0)
v_readfirstlane_b32 s74, v28
s_add_u32 s74, s74, 8
s_sub_u32 s17, s74, s101
s_cmp_lt_u32 s17, 4
s_cselect_b32 s17, 0, s17
s_cselect_b32 s74, 0x7ffffff0, 0
s_add_u32 s101, s101, s17
v_mov_b32 v33, s17
s_mov_b64 exec, 1
buffer_atomic_add v33, v23, s[44:47], s74 offen sc0 sc1
s_mov_b64 exec, -1
s_sleep 8
ds_read_b32 v28, v25
s_waitcnt vmcnt(3)
s_cmp_eq_u32 s18, 0
s_cbranch_scc1 L_skip_77
v_readfirstlane_b32 s74, v34
s_nop 1
v_add_u32 v29, s74, v1
v_add_u32 v30, s14, v27
s_add_u32 s75, s74, s18
s_cmp_ge_u32 s75, 116
s_cbranch_scc1 L_sdone_74
s_bfm_b64 exec, s18, 0
ds_write_b32 v30, v29
s_mov_b64 exec, -1
s_lshl_b32 s74, s18, 2
s_add_u32 s14, s14, s74
L_skip_77:
s_waitcnt lgkmcnt(0)
v_readfirstlane_b32 s74, v28
s_add_u32 s74, s74, 8
s_sub_u32 s18, s74, s101
s_cmp_lt_u32 s18, 4
s_cselect_b32 s18, 0, s18
s_cselect_b32 s74, 0x7ffffff0, 0
s_add_u32 s101, s101, s18
v_mov_b32 v34, s18
s_mov_b64 exec, 1
buffer_atomic_add v34, v23, s[44:47], s74 offen sc0 sc1
s_mov_b64 exec, -1
s_sleep 8
ds_read_b32 v28, v25
s_waitcnt vmcnt(3)
s_cmp_eq_u32 s19, 0
s_cbranch_scc1 L_skip_78
v_readfirstlane_b32 s74, v35
s_nop 1
v_add_u32 v29, s74, v1
v_add_u32 v30, s14, v27
s_add_u32 s75, s74, s19
s_cmp_ge_u32 s75, 116
s_cbranch_scc1 L_sdone_74
s_bfm_b64 exec, s19, 0
ds_write_b32 v30, v29
s_mov_b64 exec, -1
s_lshl_b32 s74, s19, 2
s_add_u32 s14, s14, s74
L_skip_78:
s_waitcnt lgkmcnt(0)
v_readfirstlane_b32 s74, v28
s_add_u32 s74, s74, 8
s_sub_u32 s19, s74, s101
s_cmp_lt_u32 s19, 4
s_cselect_b32 s19, 0, s19
s_cselect_b32 s74, 0x7ffffff0, 0
s_add_u32 s101, s101, s19
v_mov_b32 v35, s19
s_mov_b64 exec, 1
buffer_atomic_add v35, v23, s[44:47], s74 offen sc0 sc1
s_mov_b64 exec, -1
s_sleep 8
s_sub_u32 s93, s93, 1
s_cbranch_scc1 L_end
s_branch L_sl_73
L_sdone_74:
ds_write_b32 v30, v29
s_waitcnt vmcnt(0)
s_mov_b32 s92, 0
s_branch L_streamend_24
L_last_31:
s_mov_b32 s92, 1
s_setprio 2
L_streamend_24:
s_cmp_lt_u32 s3, 4
s_cbranch_scc1 L_skip_79
s_cmp_lg_u32 s81, 3
s_cbranch_scc1 L_skip_79
s_mov_b32 s56, s30
s_and_b32 s57, s31, 0xffff
s_mov_b32 s58, 0x1c0000
s_mov_b32 s59, 0x20000
s_lshl_b32 s76, s82, 6
s_lshl_b32 s77, s3, 7
v_lshrrev_b32 v18, 3, v1
v_mul_u32_u24 v18, 1024, v18
v_and_b32 v19, 7, v1
v_lshl_add_u32 v18, v19, 4, v18
s_mul_i32 s74, s76, 1024
s_add_u32 s74, s74, s77
s_add_u32 m0, s7, 0
s_add_u32 s75, s74, 0
buffer_load_dwordx4 v18, s[56:59], s75 offen nt lds
s_add_u32 m0, s7, 1024
s_add_u32 s75, s74, 8192
buffer_load_dwordx4 v18, s[56:59], s75 offen nt lds
s_add_u32 m0, s7, 2048
s_add_u32 s75, s74, 16384
buffer_load_dwordx4 v18, s[56:59], s75 offen nt lds
s_add_u32 m0, s7, 3072
s_add_u32 s75, s74, 24576
buffer_load_dwordx4 v18, s[56:59], s75 offen nt lds
s_add_u32 m0, s7, 4096
s_add_u32 s75, s74, 32768
buffer_load_dwordx4 v18, s[56:59], s75 offen nt lds
s_add_u32 m0, s7, 5120
s_add_u32 s75, s74, 40960
buffer_load_dwordx4 v18, s[56:59], s75 offen nt lds
s_add_u32 m0, s7, 6144
s_add_u32 s75, s74, 49152
buffer_load_dwordx4 v18, s[56:59], s75 offen nt lds
s_add_u32 m0, s7, 7168
s_add_u32 s75, s74, 57344
buffer_load_dwordx4 v18, s[56:59], s75 offen nt lds
s_lshl_b32 s92, s92, 1
L_skip_79:
v_add_f32_dpp v9, v9, v9 row_ror:4 row_mask:0xf bank_mask:0xf
s_nop 1
v_add_f32_dpp v9, v9, v9 row_ror:8 row_mask:0xf bank_mask:0xf
v_mov_b32 v12, v9
s_nop 1
v_permlane16_swap_b32 v9, v12
v_add_f32 v9, v9, v12
v_mov_b32 v12, v9
s_nop 1
v_permlane32_swap_b32 v9, v12
v_add_f32 v9, v9, v12
v_mov_b32 v14, 130048
v_mov_b32 v15, 1
s_mov_b64 exec, 15
ds_write_b32 v177, v8
ds_write_b32 v177, v9 offset:128
s_mov_b64 exec, 1
ds_add_u32 v14, v15 offset:8
s_mov_b64 exec, -1
s_cmp_eq_u32 s92, 0
s_cbranch_scc1 L_nopv_80
s_waitcnt vmcnt(8)
s_cmp_eq_u32 s92, 2
s_cbranch_scc1 L_skip_83
s_waitcnt vmcnt(0)
L_skip_83:
ds_read_b32 v16, v14 offset:8
ds_read_b128 v[208:211], v179
ds_read_b128 v[212:215], v179 offset:16
ds_read_b128 v[216:219], v179 offset:128
ds_read_b128 v[220:223], v179 offset:144
v_perm_b32 v80, v148, v144, s70
v_perm_b32 v81, v156, v152, s70
v_perm_b32 v82, v148, v144, s71
v_perm_b32 v83, v156, v152, s71
v_mfma_f32_16x16x16_bf16 v[48:51], v[80:81], v[20:21], v[48:51]
v_perm_b32 v84, v149, v145, s70
v_perm_b32 v85, v157, v153, s70
v_mfma_f32_16x16x16_bf16 v[52:55], v[82:83], v[20:21], v[52:55]
v_perm_b32 v86, v149, v145, s71
v_perm_b32 v87, v157, v153, s71
v_mfma_f32_16x16x16_bf16 v[56:59], v[84:85], v[20:21], v[56:59]
v_perm_b32 v88, v150, v146, s70
v_perm_b32 v89, v158, v154, s70
v_mfma_f32_16x16x16_bf16 v[60:63], v[86:87], v[20:21], v[60:63]
v_perm_b32 v90, v150, v146, s71
v_perm_b32 v91, v158, v154, s71
v_perm_b32 v92, v151, v147, s70
v_perm_b32 v93, v159, v155, s70
v_perm_b32 v94, v151, v147, s71
v_perm_b32 v95, v159, v155, s71
L_pj_84:
s_waitcnt lgkmcnt(0)
v_cmp_ne_u32 vcc, 8, v16
v_mfma_f32_16x16x16_bf16 v[64:67], v[88:89], v[20:21], v[64:67]
s_cbranch_vccnz L_slow_81
v_max3_f32 v24, v208, v209, v210
v_max3_f32 v25, v211, v212, v213
v_max3_f32 v24, v24, v214, v215
v_max_f32 v24, v24, v25
v_mfma_f32_16x16x16_bf16 v[68:71], v[90:91], v[20:21], v[68:71]
v_sub_f32 v208, v208, v24
v_sub_f32 v209, v209, v24
v_sub_f32 v210, v210, v24
v_sub_f32 v211, v211, v24
v_mfma_f32_16x16x16_bf16 v[72:75], v[92:93], v[20:21], v[72:75]
v_sub_f32 v212, v212, v24
v_sub_f32 v213, v213, v24
v_sub_f32 v214, v214, v24
v_sub_f32 v215, v215, v24
v_mfma_f32_16x16x16_bf16 v[76:79], v[94:95], v[20:21], v[76:79]
s_mov_b32 exec_lo, 0x000f000f
s_mov_b32 exec_hi, 0x000f000f
ds_write_b128 v176, v[48:51] offset:0
ds_write_b128 v176, v[52:55] offset:64
ds_write_b128 v176, v[56:59] offset:128
ds_write_b128 v176, v[60:63] offset:192
ds_write_b128 v176, v[64:67] offset:256
s_mov_b64 exec, -1
v_mul_f32 v208, s68, v208
v_mul_f32 v209, s68, v209
v_mul_f32 v210, s68, v210
v_mul_f32 v211, s68, v211
v_mul_f32 v212, s68, v212
v_mul_f32 v213, s68, v213
v_mul_f32 v214, s68, v214
v_mul_f32 v215, s68, v215
s_mov_b32 exec_lo, 0x000f000f
s_mov_b32 exec_hi, 0x000f000f
ds_write_b128 v176, v[68:71] offset:320
ds_write_b128 v176, v[72:75] offset:384
ds_write_b128 v176, v[76:79] offset:448
s_mov_b64 exec, -1
v_exp_f32 v208, v208
v_exp_f32 v209, v209
v_exp_f32 v210, v210
v_exp_f32 v211, v211
v_exp_f32 v212, v212
v_exp_f32 v213, v213
v_exp_f32 v214, v214
v_exp_f32 v215, v215
s_branch L_ow_82
L_slow_81:
v_mfma_f32_16x16x16_bf16 v[68:71], v[90:91], v[20:21], v[68:71]
v_mfma_f32_16x16x16_bf16 v[72:75], v[92:93], v[20:21], v[72:75]
v_mfma_f32_16x16x16_bf16 v[76:79], v[94:95], v[20:21], v[76:79]
L_nopv_80:
s_mov_b32 exec_lo, 0x000f000f
s_mov_b32 exec_hi, 0x000f000f
ds_write_b128 v176, v[48:51] offset:0
ds_write_b128 v176, v[52:55] offset:64
ds_write_b128 v176, v[56:59] offset:128
ds_write_b128 v176, v[60:63] offset:192
ds_write_b128 v176, v[64:67] offset:256
ds_write_b128 v176, v[68:71] offset:320
ds_write_b128 v176, v[72:75] offset:384
ds_write_b128 v176, v[76:79] offset:448
s_mov_b64 exec, -1
s_setprio 0
L_lw_85:
ds_read_b32 v16, v14 offset:8
s_waitcnt lgkmcnt(0)
v_cmp_eq_u32 vcc, 8, v16
s_cbranch_vccnz L_lwok_86
s_sleep 1
s_sub_u32 s93, s93, 1
s_cbranch_scc1 L_end
s_branch L_lw_85
L_lwok_86:
ds_read_b128 v[208:211], v179
ds_read_b128 v[212:215], v179 offset:16
ds_read_b128 v[216:219], v179 offset:128
ds_read_b128 v[220:223], v179 offset:144
s_waitcnt lgkmcnt(0)
v_max3_f32 v24, v208, v209, v210
v_max3_f32 v25, v211, v212, v213
v_max3_f32 v24, v24, v214, v215
v_max_f32 v24, v24, v25
v_sub_f32 v208, v208, v24
v_sub_f32 v209, v209, v24
v_sub_f32 v210, v210, v24
v_sub_f32 v211, v211, v24
v_sub_f32 v212, v212, v24
v_sub_f32 v213, v213, v24
v_sub_f32 v214, v214, v24
v_sub_f32 v215, v215, v24
v_mul_f32 v208, s68, v208
v_mul_f32 v209, s68, v209
v_mul_f32 v210, s68, v210
v_mul_f32 v211, s68, v211
v_mul_f32 v212, s68, v212
v_mul_f32 v213, s68, v213
v_mul_f32 v214, s68, v214
v_mul_f32 v215, s68, v215
v_exp_f32 v208, v208
v_exp_f32 v209, v209
v_exp_f32 v210, v210
v_exp_f32 v211, v211
v_exp_f32 v212, v212
v_exp_f32 v213, v213
v_exp_f32 v214, v214
v_exp_f32 v215, v215
L_ow_82:
s_waitcnt lgkmcnt(0)
s_barrier
ds_read_b32 v224, v178 offset:0
ds_read_b32 v225, v178 offset:2112
ds_read_b32 v226, v178 offset:4224
ds_read_b32 v227, v178 offset:6336
ds_read_b32 v228, v178 offset:8448
ds_read_b32 v229, v178 offset:10560
ds_read_b32 v230, v178 offset:12672
ds_read_b32 v231, v178 offset:14784
s_bitcmp1_b32 s3, 0
s_cbranch_scc1 L_skip_87
v_mul_f32 v25, v216, v208
v_mul_f32 v28, v217, v209
v_fmac_f32 v25, v218, v210
v_fmac_f32 v28, v219, v211
v_fmac_f32 v25, v220, v212
v_fmac_f32 v28, v221, v213
v_fmac_f32 v25, v222, v214
v_fmac_f32 v28, v223, v215
v_add_f32 v25, v25, v28
v_mov_b32 v28, 0
s_mov_b64 exec, 1
buffer_store_dwordx2 v[24:25], v28, s[44:47], s5 offen sc1
s_mov_b64 exec, -1
L_skip_87:
s_waitcnt lgkmcnt(6)
v_mul_f32 v26, v224, v208
v_mul_f32 v27, v225, v209
s_waitcnt lgkmcnt(4)
v_fmac_f32 v26, v226, v210
v_fmac_f32 v27, v227, v211
s_waitcnt lgkmcnt(2)
v_fmac_f32 v26, v228, v212
v_fmac_f32 v27, v229, v213
s_waitcnt lgkmcnt(0)
v_fmac_f32 v26, v230, v214
v_fmac_f32 v27, v231, v215
v_add_f32 v26, v26, v27
s_nop 1
v_mov_b32_dpp v27, v26 quad_perm:[1,1,3,3] row_mask:0xf bank_mask:0xf
v_cvt_pk_bf16_f32 v26, v26, v27
v_min_u32 v26, -2, v26
s_mov_b32 exec_lo, 0x55555555
s_mov_b32 exec_hi, 0x55555555
buffer_store_dword v26, v180, s[44:47], s4 offen sc1
s_mov_b64 exec, -1
s_cmp_lg_u32 s81, 3
s_cbranch_scc1 L_skip_88
s_mul_i32 s74, s3, 1024
s_add_u32 s74, s74, 1441792
v_lshl_add_u32 v4, v1, 4, s74
s_mul_i32 s74, s3, 1056
s_add_u32 s74, s74, 65536
v_lshl_add_u32 v144, v1, 4, s74
v_and_b32 v145, 7, v1
v_mul_u32_u24 v145, 1056, v145
v_lshrrev_b32 v146, 4, v1
v_lshl_add_u32 v145, v146, 4, v145
v_add_u32 v145, 65536, v145
v_and_b32 v6, 7, v1
v_mul_u32_u24 v6, 160, v6
v_lshrrev_b32 v7, 4, v1
s_lshl_b32 s74, s3, 5
s_add_u32 s74, s74, 128768
v_lshl_add_u32 v5, v7, 3, v6
v_add_u32 v5, s74, v5
v_lshl_add_u32 v6, v7, 4, v6
v_add_u32 v6, 128768, v6
s_lshl_b32 s8, s3, 15
s_lshl_b32 s74, s82, 6
s_add_u32 s8, s8, s74
s_add_u32 s8, s8, 1179648
s_add_u32 s9, s8, 8192
s_add_u32 s10, s8, 16384
s_add_u32 s11, s8, 24576
L_skip_88:
s_cmp_ge_u32 s3, 4
s_cbranch_scc1 L_wo_hi_90
ds_read_b64_tr_b16 v[96:97], v186 offset:0
ds_read_b64_tr_b16 v[98:99], v186 offset:512
ds_read_b64_tr_b16 v[100:101], v186 offset:4096
ds_read_b64_tr_b16 v[102:103], v186 offset:4608
ds_read_b64_tr_b16 v[104:105], v186 offset:8192
ds_read_b64_tr_b16 v[106:107], v186 offset:8704
ds_read_b64_tr_b16 v[108:109], v186 offset:12288
ds_read_b64_tr_b16 v[110:111], v186 offset:12800
v_mov_b32 v8, 0
v_mov_b32 v9, 0
s_cmp_lg_u32 s81, 3
s_cbranch_scc1 L_skip_91
s_lshl_b32 s78, s3, 5
s_add_u32 s78, s78, 0
v_lshrrev_b32 v12, 4, v1
v_lshlrev_b32 v12, 3, v12
v_bfe_u32 v13, v1, 2, 2
v_add_u32 v12, v12, v13
v_mul_u32_u24 v12, 128, v12
v_and_b32 v13, 3, v1
v_lshl_add_u32 v12, v13, 3, v12
v_add_u32 v12, s78, v12
ds_read_b64_tr_b16 v[192:193], v12 offset:0
ds_read_b64_tr_b16 v[194:195], v12 offset:512
ds_read_b64_tr_b16 v[196:197], v12 offset:4096
ds_read_b64_tr_b16 v[198:199], v12 offset:4608
ds_read_b64_tr_b16 v[200:201], v12 offset:8192
ds_read_b64_tr_b16 v[202:203], v12 offset:8704
ds_read_b64_tr_b16 v[204:205], v12 offset:12288
ds_read_b64_tr_b16 v[206:207], v12 offset:12800
ds_read_b64_tr_b16 v[208:209], v12 offset:16384
ds_read_b64_tr_b16 v[210:211], v12 offset:16896
ds_read_b64_tr_b16 v[212:213], v12 offset:20480
ds_read_b64_tr_b16 v[214:215], v12 offset:20992
ds_read_b64_tr_b16 v[216:217], v12 offset:24576
ds_read_b64_tr_b16 v[218:219], v12 offset:25088
ds_read_b64_tr_b16 v[220:221], v12 offset:28672
ds_read_b64_tr_b16 v[222:223], v12 offset:29184
ds_read_b64_tr_b16 v[224:225], v12 offset:32768
ds_read_b64_tr_b16 v[226:227], v12 offset:33280
ds_read_b64_tr_b16 v[228:229], v12 offset:36864
ds_read_b64_tr_b16 v[230:231], v12 offset:37376
ds_read_b64_tr_b16 v[232:233], v12 offset:40960
ds_read_b64_tr_b16 v[234:235], v12 offset:41472
ds_read_b64_tr_b16 v[236:237], v12 offset:45056
ds_read_b64_tr_b16 v[238:239], v12 offset:45568
ds_read_b64_tr_b16 v[240:241], v12 offset:49152
ds_read_b64_tr_b16 v[242:243], v12 offset:49664
ds_read_b64_tr_b16 v[244:245], v12 offset:53248
ds_read_b64_tr_b16 v[246:247], v12 offset:53760
ds_read_b64_tr_b16 v[248:249], v12 offset:57344
ds_read_b64_tr_b16 v[250:251], v12 offset:57856
ds_read_b64_tr_b16 v[252:253], v12 offset:61440
ds_read_b64_tr_b16 v[254:255], v12 offset:61952
L_skip_91:
s_waitcnt vmcnt(0)
L_pa_92:
s_mov_b32 exec_lo, 0x0f0f0f0f
s_mov_b32 exec_hi, 0x0f0f0f0f
buffer_load_dwordx2 v[8:9], v182, s[44:47], 0 offen sc1
s_mov_b64 exec, -1
buffer_load_dwordx2 v[32:33], v181, s[44:47], 0 offen offset:0 sc1
buffer_load_dwordx2 v[34:35], v181, s[44:47], 0 offen offset:1024 sc1
buffer_load_dwordx2 v[36:37], v181, s[44:47], 0 offen offset:2048 sc1
buffer_load_dwordx2 v[38:39], v181, s[44:47], 0 offen offset:3072 sc1
s_waitcnt vmcnt(4)
v_max_f32_dpp v12, v8, v8 quad_perm:[1,0,3,2] row_mask:0xf bank_mask:0xf
v_max_u32 v13, v8, v9
s_nop 0
v_max_f32_dpp v12, v12, v12 quad_perm:[2,3,0,1] row_mask:0xf bank_mask:0xf
v_sub_f32 v10, v8, v12
v_mul_f32 v10, s68, v10
v_exp_f32 v10, v10
s_nop 0
v_mul_f32 v12, v10, v9
s_nop 1
v_add_f32_dpp v12, v12, v12 quad_perm:[1,0,3,2] row_mask:0xf bank_mask:0xf
s_nop 1
v_add_f32_dpp v12, v12, v12 quad_perm:[2,3,0,1] row_mask:0xf bank_mask:0xf
v_rcp_f32 v12, v12
s_nop 0
v_mul_f32 v10, v10, v12
s_nop 1
v_mov_b32_dpp v10, v10 row_shr:4 row_mask:0xf bank_mask:0xa
s_waitcnt vmcnt(0)
v_max3_u32 v14, v32, v33, v34
v_max3_u32 v13, v13, v35, v36
v_max3_u32 v14, v14, v37, v38
v_max3_u32 v13, v13, v14, v39
v_cmp_eq_u32 vcc, -1, v13
v_lshlrev_b32 v16, 16, v32
v_and_b32 v17, s69, v32
v_lshlrev_b32 v18, 16, v33
v_and_b32 v19, s69, v33
v_lshlrev_b32 v20, 16, v34
v_and_b32 v21, s69, v34
v_lshlrev_b32 v22, 16, v35
v_and_b32 v23, s69, v35
v_lshlrev_b32 v24, 16, v36
v_and_b32 v25, s69, v36
v_lshlrev_b32 v26, 16, v37
v_and_b32 v27, s69, v37
v_lshlrev_b32 v28, 16, v38
v_and_b32 v29, s69, v38
v_lshlrev_b32 v30, 16, v39
v_and_b32 v31, s69, v39
s_cbranch_vccz L_paok_93
s_sub_u32 s93, s93, 1
s_cbranch_scc1 L_end
s_branch L_pa_92
L_paok_93:
v_mul_f32_dpp v16, v10, v16 quad_perm:[0,0,0,0] row_mask:0xf bank_mask:0xf
v_mul_f32_dpp v17, v10, v17 quad_perm:[0,0,0,0] row_mask:0xf bank_mask:0xf
v_mul_f32_dpp v18, v10, v18 quad_perm:[0,0,0,0] row_mask:0xf bank_mask:0xf
v_mul_f32_dpp v19, v10, v19 quad_perm:[0,0,0,0] row_mask:0xf bank_mask:0xf
v_fmac_f32_dpp v16, v10, v20 quad_perm:[1,1,1,1] row_mask:0xf bank_mask:0xf
v_fmac_f32_dpp v17, v10, v21 quad_perm:[1,1,1,1] row_mask:0xf bank_mask:0xf
v_fmac_f32_dpp v18, v10, v22 quad_perm:[1,1,1,1] row_mask:0xf bank_mask:0xf
v_fmac_f32_dpp v19, v10, v23 quad_perm:[1,1,1,1] row_mask:0xf bank_mask:0xf
v_fmac_f32_dpp v16, v10, v24 quad_perm:[2,2,2,2] row_mask:0xf bank_mask:0xf
v_fmac_f32_dpp v17, v10, v25 quad_perm:[2,2,2,2] row_mask:0xf bank_mask:0xf
v_fmac_f32_dpp v18, v10, v26 quad_perm:[2,2,2,2] row_mask:0xf bank_mask:0xf
v_fmac_f32_dpp v19, v10, v27 quad_perm:[2,2,2,2] row_mask:0xf bank_mask:0xf
v_fmac_f32_dpp v16, v10, v28 quad_perm:[3,3,3,3] row_mask:0xf bank_mask:0xf
v_fmac_f32_dpp v17, v10, v29 quad_perm:[3,3,3,3] row_mask:0xf bank_mask:0xf
v_fmac_f32_dpp v18, v10, v30 quad_perm:[3,3,3,3] row_mask:0xf bank_mask:0xf
v_fmac_f32_dpp v19, v10, v31 quad_perm:[3,3,3,3] row_mask:0xf bank_mask:0xf
v_cvt_pk_bf16_f32 v16, v16, v17
v_cvt_pk_bf16_f32 v17, v18, v19
ds_write_b64 v183, v[16:17]
s_waitcnt lgkmcnt(0)
s_barrier
ds_read_b128 v[16:19], v184 offset:0
ds_read_b128 v[20:23], v184 offset:768
ds_read_b128 v[24:27], v184 offset:1536
ds_read_b128 v[28:31], v184 offset:2304
s_waitcnt lgkmcnt(3)
v_mfma_f32_16x16x32_bf16 v[40:43], v[96:99], v[16:19], 0
s_waitcnt lgkmcnt(2)
v_mfma_f32_16x16x32_bf16 v[40:43], v[100:103], v[20:23], v[40:43]
s_waitcnt lgkmcnt(1)
v_mfma_f32_16x16x32_bf16 v[40:43], v[104:107], v[24:27], v[40:43]
s_waitcnt lgkmcnt(0)
v_mfma_f32_16x16x32_bf16 v[40:43], v[108:111], v[28:31], v[40:43]
s_mov_b32 exec_lo, 0x00ff00ff
s_mov_b32 exec_hi, 0x00ff00ff
s_nop 5
v_cvt_pk_bf16_f32 v40, v40, v41
v_cvt_pk_bf16_f32 v41, v42, v43
v_min_u32 v40, -2, v40
v_min_u32 v41, -2, v41
buffer_store_dwordx2 v[40:41], v187, s[44:47], s6 offen sc1
s_mov_b64 exec, -1
s_cmp_lt_u32 s81, 3
s_cbranch_scc1 L_skip_94
v_mov_b32 v14, 130048
s_waitcnt vmcnt(0)
ds_write_b32 v14, v14 offset:20
L_skip_94:
s_cmp_lg_u32 s81, 3
s_cbranch_scc1 L_fin_97
v_mov_b32 v14, 130048
L_lw_98:
ds_read_b32 v15, v14 offset:16
s_waitcnt lgkmcnt(0)
v_cmp_ne_u32 vcc, 0, v15
s_cbranch_vccnz L_lwok_99
s_sleep 1
s_sub_u32 s93, s93, 1
s_cbranch_scc1 L_end
s_branch L_lw_98
L_lwok_99:
s_branch L_ffn_95
L_wo_hi_90:
s_barrier
s_cmp_lg_u32 s81, 3
s_cbranch_scc1 L_skip_100
s_waitcnt vmcnt(0)
v_lshrrev_b32 v12, 4, v1
v_lshlrev_b32 v12, 3, v12
v_bfe_u32 v13, v1, 2, 2
v_add_u32 v12, v12, v13
v_mul_u32_u24 v12, 128, v12
v_and_b32 v13, 3, v1
v_lshl_add_u32 v12, v13, 3, v12
v_add_u32 v12, s7, v12
ds_read_b64_tr_b16 v[112:113], v12 offset:0
ds_read_b64_tr_b16 v[114:115], v12 offset:512
ds_read_b64_tr_b16 v[116:117], v12 offset:32
ds_read_b64_tr_b16 v[118:119], v12 offset:544
ds_read_b64_tr_b16 v[120:121], v12 offset:64
ds_read_b64_tr_b16 v[122:123], v12 offset:576
ds_read_b64_tr_b16 v[124:125], v12 offset:96
ds_read_b64_tr_b16 v[126:127], v12 offset:608
ds_read_b64_tr_b16 v[128:129], v12 offset:4096
ds_read_b64_tr_b16 v[130:131], v12 offset:4608
ds_read_b64_tr_b16 v[132:133], v12 offset:4128
ds_read_b64_tr_b16 v[134:135], v12 offset:4640
ds_read_b64_tr_b16 v[136:137], v12 offset:4160
ds_read_b64_tr_b16 v[138:139], v12 offset:4672
ds_read_b64_tr_b16 v[140:141], v12 offset:4192
ds_read_b64_tr_b16 v[142:143], v12 offset:4704
L_skip_100:
s_cmp_lt_u32 s81, 3
s_cbranch_scc1 L_fin_97
s_mov_b32 s60, s36
s_and_b32 s61, s37, 0xffff
s_mov_b32 s62, 0x2000
s_mov_b32 s63, 0x20000
s_mov_b32 s77, 1441792
v_mov_b32 v14, 130048
L_lw_101:
ds_read_b32 v15, v14 offset:20
s_waitcnt lgkmcnt(0)
v_cmp_ne_u32 vcc, 0, v15
s_cbranch_vccnz L_lwok_102
s_sleep 1
s_sub_u32 s93, s93, 1
s_cbranch_scc1 L_end
s_branch L_lw_101
L_lwok_102:
L_poll_103:
buffer_load_dwordx2 v[32:33], v204, s[44:47], 0 offen offset:0 sc1
buffer_load_dwordx2 v[34:35], v204, s[44:47], 0 offen offset:512 sc1
buffer_load_dwordx2 v[36:37], v204, s[44:47], 0 offen offset:1024 sc1
buffer_load_dwordx2 v[38:39], v204, s[44:47], 0 offen offset:1536 sc1
s_waitcnt vmcnt(0)
L_pollchk_105:
v_max3_u32 v12, v32, v33, v34
v_max3_u32 v13, v35, v36, v37
v_max3_u32 v12, v12, v38, v39
v_max_u32 v12, v12, v13
v_cmp_eq_u32 vcc, -1, v12
s_cbranch_vccz L_pollok_104
s_sub_u32 s93, s93, 1
s_cbranch_scc1 L_end
s_branch L_poll_103
L_pollok_104:
v_lshlrev_b32 v16, 16, v32
v_and_b32 v17, s69, v32
v_lshlrev_b32 v18, 16, v33
v_and_b32 v19, s69, v33
v_lshlrev_b32 v20, 16, v34
v_and_b32 v21, s69, v34
v_lshlrev_b32 v22, 16, v35
v_and_b32 v23, s69, v35
v_lshlrev_b32 v24, 16, v36
v_and_b32 v25, s69, v36
v_lshlrev_b32 v26, 16, v37
v_and_b32 v27, s69, v37
v_lshlrev_b32 v28, 16, v38
v_and_b32 v29, s69, v38
v_lshlrev_b32 v30, 16, v39
v_and_b32 v31, s69, v39
v_pk_add_f32 v[16:17], v[16:17], v[24:25]
v_pk_add_f32 v[18:19], v[18:19], v[26:27]
v_pk_add_f32 v[20:21], v[20:21], v[28:29]
v_pk_add_f32 v[22:23], v[22:23], v[30:31]
v_pk_add_f32 v[16:17], v[16:17], v[20:21]
v_pk_add_f32 v[18:19], v[18:19], v[22:23]
s_nop 1
v_permlane32_swap_b32 v16, v18
v_permlane32_swap_b32 v17, v19
v_pk_add_f32 v[16:17], v[16:17], v[18:19]
s_nop 1
v_permlane16_swap_b32 v16, v17
v_add_f32 v16, v16, v17
s_nop 1
v_add_f32_dpp v16, v16, v16 row_ror:8 row_mask:0xf bank_mask:0xf
v_cvt_pk_bf16_f32 v16, v16, v16
v_and_b32 v16, s69, v16
v_mul_f32 v16, v16, v188
v_cvt_pk_bf16_f32 v16, v16, v16
v_and_b32 v16, s69, v16
v_add_f32 v16, v16, v190
v_mov_b32 v18, v16
v_mov_b32 v19, v16
s_nop 1
v_permlane16_swap_b32 v18, v19
v_cvt_pk_bf16_f32 v20, v18, v19
v_min_u32 v20, -2, v20
v_mov_b32 v21, v20
s_nop 1
v_permlane32_swap_b32 v20, v21
s_mov_b64 exec, 0xff
s_cmp_lg_u32 s15, 2
s_cbranch_scc1 L_far_106
buffer_store_dwordx2 v[20:21], v206, s[44:47], s77 offen
s_branch L_pub_107
L_far_106:
buffer_store_dwordx2 v[20:21], v206, s[44:47], s77 offen sc1
L_pub_107:
s_waitcnt vmcnt(0)
v_mov_b32 v14, 130048
ds_write_b32 v14, v14 offset:16
s_mov_b64 exec, -1
v_cvt_pk_bf16_f32 v16, v16, v16
v_and_b32 v16, s69, v16
v_mov_b32 v190, v16
s_cmp_lg_u32 s82, 31
s_cbranch_scc1 L_skip_108
s_cmp_lg_u32 s3, 4
s_cbranch_scc1 L_skip_108
v_readfirstlane_b32 s80, v47
s_mul_i32 s80, s80, 0x9e3779b1
s_add_u32 s80, s80, 0x7f4a7c15
s_mov_b64 exec, 1
v_mov_b32 v12, s80
v_mov_b32 v13, 1835008
buffer_store_dword v12, v13, s[44:47], 0 offen sc1
s_mov_b64 exec, -1
L_skip_108:
s_cmp_lg_u32 s81, 3
s_cbranch_scc1 L_c_96
L_ffn_95:
L_poll_109:
buffer_load_dwordx4 v[8:11], v4, s[44:47], 0 offen sc1
s_waitcnt vmcnt(0)
L_pollchk_111:
v_max3_u32 v12, v8, v9, v10
v_max_u32 v13, v11, v11
v_max_u32 v12, v12, v13
v_cmp_eq_u32 vcc, -1, v12
s_cbranch_vccz L_pollok_110
s_sub_u32 s93, s93, 1
s_cbranch_scc1 L_end
s_branch L_poll_109
L_pollok_110:
v_readfirstlane_b32 s76, v8
v_lshlrev_b32 v16, 16, v8
v_and_b32 v17, s69, v8
v_lshlrev_b32 v18, 16, v9
v_and_b32 v19, s69, v9
v_lshlrev_b32 v20, 16, v10
v_and_b32 v21, s69, v10
v_lshlrev_b32 v22, 16, v11
v_and_b32 v23, s69, v11
s_lshl_b32 s76, s76, 16
v_mov_b32 v36, s76
v_pk_add_f32 v[26:27], v[16:17], v[36:37] op_sel_hi:[1,0] neg_lo:[0,1] neg_hi:[0,1]
v_pk_add_f32 v[28:29], v[18:19], v[36:37] op_sel_hi:[1,0] neg_lo:[0,1] neg_hi:[0,1]
v_pk_add_f32 v[30:31], v[20:21], v[36:37] op_sel_hi:[1,0] neg_lo:[0,1] neg_hi:[0,1]
v_pk_add_f32 v[32:33], v[22:23], v[36:37] op_sel_hi:[1,0] neg_lo:[0,1] neg_hi:[0,1]
v_pk_add_f32 v[24:25], v[26:27], v[28:29]
v_pk_mul_f32 v[34:35], v[26:27], v[26:27]
v_pk_add_f32 v[24:25], v[24:25], v[30:31]
v_pk_fma_f32 v[34:35], v[28:29], v[28:29], v[34:35]
v_pk_add_f32 v[24:25], v[24:25], v[32:33]
v_pk_fma_f32 v[34:35], v[30:31], v[30:31], v[34:35]
v_add_f32 v24, v24, v25
v_pk_fma_f32 v[34:35], v[32:33], v[32:33], v[34:35]
v_add_f32 v25, v34, v35
s_nop 1
v_permlane32_swap_b32 v24, v25
v_add_f32 v24, v24, v25
s_nop 1
v_add_f32_dpp v24, v24, v24 row_ror:8 row_mask:0xf bank_mask:0xf
s_nop 1
v_add_f32_dpp v24, v24, v24 row_ror:4 row_mask:0xf bank_mask:0xf
s_nop 1
v_add_f32_dpp v24, v24, v24 row_ror:2 row_mask:0xf bank_mask:0xf
s_nop 1
v_add_f32_dpp v24, v24, v24 row_ror:1 row_mask:0xf bank_mask:0xf
v_mov_b32 v25, v24
s_nop 1
v_permlane16_swap_b32 v24, v25
v_add_f32 v24, v24, v25
v_mul_f32 v24, 0x3b000000, v24
v_mov_b32 v25, v24
s_nop 1
v_permlane32_swap_b32 v24, v25
v_fma_f32 v25, -v24, v24, v25
v_add_f32 v24, v36, v24
v_max_f32 v25, 0, v25
v_cvt_pk_bf16_f32 v24, v24, v25
v_and_b32 v25, s69, v24
v_lshlrev_b32 v24, 16, v24
v_add_f32 v25, 0x3727c5ac, v25
v_cvt_pk_bf16_f32 v25, v25, v25
v_and_b32 v25, s69, v25
v_sqrt_f32 v25, v25
s_nop 0
v_pk_add_f32 v[16:17], v[16:17], v[24:25] op_sel_hi:[1,0] neg_lo:[0,1] neg_hi:[0,1]
v_pk_add_f32 v[18:19], v[18:19], v[24:25] op_sel_hi:[1,0] neg_lo:[0,1] neg_hi:[0,1]
v_cvt_pk_bf16_f32 v25, v25, v25
v_and_b32 v25, s69, v25
v_rcp_f32 v36, v25
v_pk_add_f32 v[20:21], v[20:21], v[24:25] op_sel_hi:[1,0] neg_lo:[0,1] neg_hi:[0,1]
v_pk_add_f32 v[22:23], v[22:23], v[24:25] op_sel_hi:[1,0] neg_lo:[0,1] neg_hi:[0,1]
v_pk_mul_f32 v[16:17], v[16:17], v[36:37] op_sel_hi:[1,0]
v_pk_mul_f32 v[18:19], v[18:19], v[36:37] op_sel_hi:[1,0]
v_pk_mul_f32 v[20:21], v[20:21], v[36:37] op_sel_hi:[1,0]
v_pk_mul_f32 v[22:23], v[22:23], v[36:37] op_sel_hi:[1,0]
v_pk_fma_f32 v[16:17], v[16:17], v[160:161], v[168:169]
v_pk_fma_f32 v[18:19], v[18:19], v[162:163], v[170:171]
v_pk_fma_f32 v[20:21], v[20:21], v[164:165], v[172:173]
v_pk_fma_f32 v[22:23], v[22:23], v[166:167], v[174:175]
v_cvt_pk_bf16_f32 v12, v16, v17
v_cvt_pk_bf16_f32 v13, v18, v19
v_cvt_pk_bf16_f32 v14, v20, v21
v_cvt_pk_bf16_f32 v15, v22, v23
ds_write_b128 v144, v[12:15]
s_waitcnt lgkmcnt(0)
s_barrier
s_cmp_ge_u32 s3, 4
s_cbranch_scc1 L_skip_112
ds_read_b128 v[16:19], v145 offset:0
ds_read_b128 v[20:23], v145 offset:64
ds_read_b128 v[24:27], v145 offset:128
ds_read_b128 v[28:31], v145 offset:192
ds_read_b128 v[32:35], v145 offset:256
ds_read_b128 v[36:39], v145 offset:320
ds_read_b128 v[40:43], v145 offset:384
ds_read_b128 v[44:47], v145 offset:448
ds_read_b128 v[48:51], v145 offset:512
ds_read_b128 v[52:55], v145 offset:576
ds_read_b128 v[56:59], v145 offset:640
ds_read_b128 v[60:63], v145 offset:704
ds_read_b128 v[64:67], v145 offset:768
ds_read_b128 v[68:71], v145 offset:832
ds_read_b128 v[72:75], v145 offset:896
ds_read_b128 v[76:79], v145 offset:960
s_waitcnt lgkmcnt(15)
v_mfma_f32_16x16x32_bf16 v[8:11], v[192:195], v[16:19], 0
s_waitcnt lgkmcnt(14)
v_mfma_f32_16x16x32_bf16 v[8:11], v[196:199], v[20:23], v[8:11]
s_waitcnt lgkmcnt(13)
v_mfma_f32_16x16x32_bf16 v[8:11], v[200:203], v[24:27], v[8:11]
s_waitcnt lgkmcnt(12)
v_mfma_f32_16x16x32_bf16 v[8:11], v[204:207], v[28:31], v[8:11]
s_waitcnt lgkmcnt(11)
v_mfma_f32_16x16x32_bf16 v[8:11], v[208:211], v[32:35], v[8:11]
s_waitcnt lgkmcnt(10)
v_mfma_f32_16x16x32_bf16 v[8:11], v[212:215], v[36:39], v[8:11]
s_waitcnt lgkmcnt(9)
v_mfma_f32_16x16x32_bf16 v[8:11], v[216:219], v[40:43], v[8:11]
s_waitcnt lgkmcnt(8)
v_mfma_f32_16x16x32_bf16 v[8:11], v[220:223], v[44:47], v[8:11]
s_waitcnt lgkmcnt(7)
v_mfma_f32_16x16x32_bf16 v[8:11], v[224:227], v[48:51], v[8:11]
s_waitcnt lgkmcnt(6)
v_mfma_f32_16x16x32_bf16 v[8:11], v[228:231], v[52:55], v[8:11]
s_waitcnt lgkmcnt(5)
v_mfma_f32_16x16x32_bf16 v[8:11], v[232:235], v[56:59], v[8:11]
s_waitcnt lgkmcnt(4)
v_mfma_f32_16x16x32_bf16 v[8:11], v[236:239], v[60:63], v[8:11]
s_waitcnt lgkmcnt(3)
v_mfma_f32_16x16x32_bf16 v[8:11], v[240:243], v[64:67], v[8:11]
s_waitcnt lgkmcnt(2)
v_mfma_f32_16x16x32_bf16 v[8:11], v[244:247], v[68:71], v[8:11]
s_waitcnt lgkmcnt(1)
v_mfma_f32_16x16x32_bf16 v[8:11], v[248:251], v[72:75], v[8:11]
s_waitcnt lgkmcnt(0)
v_mfma_f32_16x16x32_bf16 v[8:11], v[252:255], v[76:79], v[8:11]
s_nop 7
v_max_f32 v8, 0, v8
v_max_f32 v9, 0, v9
v_max_f32 v10, 0, v10
v_max_f32 v11, 0, v11
v_cvt_pk_bf16_f32 v8, v8, v9
v_cvt_pk_bf16_f32 v9, v10, v11
s_mov_b32 exec_lo, 0x00ff00ff
s_mov_b32 exec_hi, 0x00ff00ff
ds_write_b64 v5, v[8:9]
s_mov_b64 exec, -1
L_skip_112:
s_waitcnt lgkmcnt(0)
s_barrier
ds_read_b128 v[16:19], v6
ds_read_b128 v[20:23], v6 offset:64
s_waitcnt lgkmcnt(1)
v_mfma_f32_16x16x32_bf16 v[24:27], v[112:115], v[16:19], 0
v_mfma_f32_16x16x32_bf16 v[28:31], v[116:119], v[16:19], 0
v_mfma_f32_16x16x32_bf16 v[32:35], v[120:123], v[16:19], 0
v_mfma_f32_16x16x32_bf16 v[36:39], v[124:127], v[16:19], 0
s_waitcnt lgkmcnt(0)
v_mfma_f32_16x16x32_bf16 v[24:27], v[128:131], v[20:23], v[24:27]
v_mfma_f32_16x16x32_bf16 v[28:31], v[132:135], v[20:23], v[28:31]
v_mfma_f32_16x16x32_bf16 v[32:35], v[136:139], v[20:23], v[32:35]
v_mfma_f32_16x16x32_bf16 v[36:39], v[140:143], v[20:23], v[36:39]
s_mov_b32 exec_lo, 0x00ff00ff
s_mov_b32 exec_hi, 0x00ff00ff
s_cmp_lg_u32 s15, 2
s_cbranch_scc1 L_far_113
s_nop 0
v_cvt_pk_bf16_f32 v24, v24, v25
v_cvt_pk_bf16_f32 v25, v26, v27
v_min_u32 v24, -2, v24
v_min_u32 v25, -2, v25
buffer_store_dwordx2 v[24:25], v187, s[44:47], s8 offen
v_cvt_pk_bf16_f32 v28, v28, v29
v_cvt_pk_bf16_f32 v29, v30, v31
v_min_u32 v28, -2, v28
v_min_u32 v29, -2, v29
buffer_store_dwordx2 v[28:29], v187, s[44:47], s9 offen
v_cvt_pk_bf16_f32 v32, v32, v33
v_cvt_pk_bf16_f32 v33, v34, v35
v_min_u32 v32, -2, v32
v_min_u32 v33, -2, v33
buffer_store_dwordx2 v[32:33], v187, s[44:47], s10 offen
v_cvt_pk_bf16_f32 v36, v36, v37
v_cvt_pk_bf16_f32 v37, v38, v39
v_min_u32 v36, -2, v36
v_min_u32 v37, -2, v37
buffer_store_dwordx2 v[36:37], v187, s[44:47], s11 offen
s_branch L_pub_114
L_far_113:
s_nop 0
v_cvt_pk_bf16_f32 v24, v24, v25
v_cvt_pk_bf16_f32 v25, v26, v27
v_min_u32 v24, -2, v24
v_min_u32 v25, -2, v25
buffer_store_dwordx2 v[24:25], v187, s[44:47], s8 offen sc1
v_cvt_pk_bf16_f32 v28, v28, v29
v_cvt_pk_bf16_f32 v29, v30, v31
v_min_u32 v28, -2, v28
v_min_u32 v29, -2, v29
buffer_store_dwordx2 v[28:29], v187, s[44:47], s9 offen sc1
v_cvt_pk_bf16_f32 v32, v32, v33
v_cvt_pk_bf16_f32 v33, v34, v35
v_min_u32 v32, -2, v32
v_min_u32 v33, -2, v33
buffer_store_dwordx2 v[32:33], v187, s[44:47], s10 offen sc1
v_cvt_pk_bf16_f32 v36, v36, v37
v_cvt_pk_bf16_f32 v37, v38, v39
v_min_u32 v36, -2, v36
v_min_u32 v37, -2, v37
buffer_store_dwordx2 v[36:37], v187, s[44:47], s11 offen sc1
L_pub_114:
s_mov_b64 exec, -1
s_cmp_lt_u32 s3, 4
s_cbranch_scc1 L_fin_97
L_c_96:
v_mov_b32 v38, 0
v_mov_b32 v39, 0
s_waitcnt vmcnt(0)
L_poll_115:
buffer_load_dwordx2 v[32:33], v205, s[44:47], 0 offen offset:0 sc1
buffer_load_dwordx2 v[34:35], v205, s[44:47], 0 offen offset:512 sc1
buffer_load_dwordx2 v[36:37], v205, s[44:47], 0 offen offset:1024 sc1
s_mov_b32 exec_hi, 0
buffer_load_dwordx2 v[38:39], v205, s[44:47], 0 offen offset:1536 sc1
s_mov_b32 exec_hi, -1
s_waitcnt vmcnt(0)
L_pollchk_117:
v_max3_u32 v12, v32, v33, v34
v_max3_u32 v13, v35, v36, v37
v_max3_u32 v12, v12, v38, v39
v_max_u32 v12, v12, v13
v_cmp_eq_u32 vcc, -1, v12
s_cbranch_vccz L_pollok_116
s_sub_u32 s93, s93, 1
s_cbranch_scc1 L_end
s_branch L_poll_115
L_pollok_116:
v_lshlrev_b32 v16, 16, v32
v_and_b32 v17, s69, v32
v_lshlrev_b32 v18, 16, v33
v_and_b32 v19, s69, v33
v_lshlrev_b32 v20, 16, v34
v_and_b32 v21, s69, v34
v_lshlrev_b32 v22, 16, v35
v_and_b32 v23, s69, v35
v_lshlrev_b32 v24, 16, v36
v_and_b32 v25, s69, v36
v_lshlrev_b32 v26, 16, v37
v_and_b32 v27, s69, v37
v_lshlrev_b32 v28, 16, v38
v_and_b32 v29, s69, v38
v_lshlrev_b32 v30, 16, v39
v_and_b32 v31, s69, v39
v_pk_add_f32 v[16:17], v[16:17], v[24:25]
v_pk_add_f32 v[18:19], v[18:19], v[26:27]
v_pk_add_f32 v[20:21], v[20:21], v[28:29]
v_pk_add_f32 v[22:23], v[22:23], v[30:31]
v_pk_add_f32 v[16:17], v[16:17], v[20:21]
v_pk_add_f32 v[18:19], v[18:19], v[22:23]
s_nop 1
v_permlane32_swap_b32 v16, v18
v_permlane32_swap_b32 v17, v19
v_pk_add_f32 v[16:17], v[16:17], v[18:19]
s_nop 1
v_permlane16_swap_b32 v16, v17
v_add_f32 v16, v16, v17
s_nop 1
v_add_f32_dpp v16, v16, v16 row_ror:8 row_mask:0xf bank_mask:0xf
v_cvt_pk_bf16_f32 v16, v16, v16
v_and_b32 v16, s69, v16
v_mul_f32 v16, v16, v189
v_cvt_pk_bf16_f32 v16, v16, v16
v_and_b32 v16, s69, v16
v_add_f32 v16, v16, v190
v_mov_b32 v18, v16
v_mov_b32 v19, v16
s_nop 1
v_permlane16_swap_b32 v18, v19
v_cvt_pk_bf16_f32 v20, v18, v19
v_min_u32 v20, -2, v20
v_mov_b32 v21, v20
s_nop 1
v_permlane32_swap_b32 v20, v21
s_mov_b64 exec, 0xff
buffer_store_dwordx2 v[20:21], v206, s[60:63], 0 offen
L_fin_97:
L_end:
s_endpgm
.p2align 6
.type L_roles,@object
L_roles:
.long 0x31000, 0x2001, 0x2000, 0x1002, 0x2012, 0x1000, 0x1000, 0x2000
.long 0x132000, 0x1011, 0x1032, 0x2000, 0x1000, 0x2022, 0x2000, 0x1000
.long 0x233000, 0x2021, 0x2000, 0x3000, 0x2052, 0x3000, 0x3042, 0x2000
.long 0x331000, 0x1031, 0x1072, 0x1062, 0x1000, 0x1000, 0x1000, 0x1000
.long 0x432000, 0x2041, 0x2000, 0x2000, 0x2092, 0x2082, 0x2000, 0x2000
.long 0x533000, 0x1051, 0x10b2, 0x3000, 0x1000, 0x3000, 0x30a2, 0x1000
.long 0x631000, 0x2061, 0x2000, 0x10c2, 0x20d2, 0x1000, 0x1000, 0x2000
.long 0x732000, 0x1071, 0x10f2, 0x2000, 0x1000, 0x20e2, 0x2000, 0x1000
.long 0x833000, 0x2081, 0x2000, 0x3000, 0x2112, 0x3000, 0x3102, 0x2000
.long 0x931000, 0x1091, 0x1132, 0x1122, 0x1000, 0x1000, 0x1000, 0x1000
.long 0xa32000, 0x20a1, 0x2000, 0x2000, 0x2152, 0x2142, 0x2000, 0x2000
.long 0xb33000, 0x10b1, 0x1172, 0x3000, 0x1000, 0x3000, 0x3162, 0x1000
.long 0xc31000, 0x20c1, 0x2000, 0x1182, 0x2192, 0x1000, 0x1000, 0x2000
.long 0xd32000, 0x10d1, 0x11b2, 0x2000, 0x1000, 0x21a2, 0x2000, 0x1000
.long 0xe33000, 0x20e1, 0x2000, 0x3000, 0x21d2, 0x3000, 0x31c2, 0x2000
.long 0xf31000, 0x10f1, 0x11f2, 0x11e2, 0x1000, 0x1000, 0x1000, 0x1000
.long 0x1032000, 0x2101, 0x2000, 0x2000, 0x2212, 0x2202, 0x2000, 0x2201
.long 0x1133000, 0x1111, 0x1232, 0x3000, 0x1000, 0x3000, 0x3222, 0x1211
.long 0x1231000, 0x2121, 0x2000, 0x1242, 0x2252, 0x1000, 0x1000, 0x2221
.long 0x1332000, 0x1131, 0x1272, 0x2000, 0x1000, 0x2262, 0x2000, 0x1231
.long 0x1433000, 0x2141, 0x2000, 0x3000, 0x2292, 0x3000, 0x3282, 0x2241
.long 0x1531000, 0x1151, 0x12b2, 0x12a2, 0x1000, 0x1000, 0x1000, 0x1251
.long 0x1632000, 0x2161, 0x2000, 0x2000, 0x22d2, 0x22c2, 0x2000, 0x2261
.long 0x1733000, 0x1171, 0x12f2, 0x3000, 0x1000, 0x3000, 0x32e2, 0x1271
.long 0x1831000, 0x2181, 0x2000, 0x1302, 0x2312, 0x1000, 0x1000, 0x2281
.long 0x1932000, 0x1191, 0x1332, 0x2000, 0x1000, 0x2322, 0x2000, 0x1291
.long 0x1a33000, 0x21a1, 0x2000, 0x3000, 0x2352, 0x3000, 0x3342, 0x22a1
.long 0x1b31000, 0x11b1, 0x1372, 0x1362, 0x1000, 0x1000, 0x1000, 0x12b1
.long 0x1c422c1, 0x21c1, 0x2000, 0x2000, 0x2392, 0x2382, 0x2000, 0x2000
.long 0x1d432d1, 0x11d1, 0x13b2, 0x3000, 0x1000, 0x3000, 0x33a2, 0x1000
.long 0x1e412e1, 0x21e1, 0x2000, 0x13c2, 0x23d2, 0x1000, 0x1000, 0x2000
.long 0x1f422f1, 0x11f1, 0x13f2, 0x2000, 0x1000, 0x23e2, 0x2000, 0x1000
.size L_roles, 1024
.section .rodata,"a"
.p2align 6
.amdhsa_kernel adaLN_cond__gqa_block_cached__dense_activation_relu__decode_kernel
  .amdhsa_next_free_vgpr 256
  .amdhsa_next_free_sgpr 102
  .amdhsa_accum_offset 256
  .amdhsa_group_segment_fixed_size 0
  .amdhsa_kernarg_size 104
  .amdhsa_user_sgpr_count 2
  .amdhsa_user_sgpr_kernarg_segment_ptr 1
  .amdhsa_system_sgpr_workgroup_id_x 1
  .amdhsa_float_denorm_mode_32 3
.end_amdhsa_kernel
```
